```python
import torch

def _softmax(x, axis=-1):
    return torch.softmax(x, dim=axis)
def _gelu(x):
    return torch.nn.functional.gelu(x, approximate="tanh")
def _silu(x):
    return torch.nn.functional.silu(x)
def _sigmoid(x):
    return torch.sigmoid(x)
def _layernorm(x, axis=-1, eps=1e-5):
    m = x.mean(dim=axis, keepdim=True)
    v = x.var(dim=axis, keepdim=True, unbiased=False)
    return (x - m) / torch.sqrt(v + eps)
def _scatter_add(tgt, idx, src, axis=0):
    return tgt.clone().index_add_(axis, idx, src)
def _segment_sum(src, seg, n):
    out = torch.zeros((n,) + src.shape[1:], dtype=src.dtype)
    return out.index_add_(0, seg, src)
def _pad(x, pw):
    flat = tuple(v for pair in reversed(pw) for v in pair)
    return torch.nn.functional.pad(x, flat)

kernel_name = 'interleave_layers__linear_attn_block__dense_activation_silu__prompt'

def setup_inputs():

    _w = (lambda a: (lambda t: t.to(torch.bfloat16) if t.is_floating_point() else t)(torch.as_tensor(a)))
    def _A_setup():
        B, S, D = 1, 2048, 576
        return {
            "x": _w((lambda *s: torch.randn(*s, dtype=torch.bfloat16) * 0.05)(B, S, D)),
            "wqkv": _w((lambda *s: torch.randn(*s, dtype=torch.bfloat16) * 0.05)(D, 3 * D)),
            "wo": _w((lambda *s: torch.randn(*s, dtype=torch.bfloat16) * 0.05)(D, D)),
        }
    _A_in = _A_setup()

    def _B_setup():
        B, S, D, F = 1, 2048, 576, 4608
        return {
            "x": _w((lambda *s: torch.randn(*s, dtype=torch.bfloat16) * 0.05)(B, S, D)),
            "w1": _w((lambda *s: torch.randn(*s, dtype=torch.bfloat16) * 0.8)(D, F) * (D ** -0.5)),
            "w2": _w((lambda *s: torch.randn(*s, dtype=torch.bfloat16) * 0.8)(F, D) * (F ** -0.5)),
        }
    _B_in = _B_setup()

    return {
        "A_x": _A_in["x"],
        "A_wqkv": _A_in["wqkv"],
        "A_wo": _A_in["wo"],
        "B_x": _B_in["x"],
        "B_w1": _B_in["w1"],
        "B_w2": _B_in["w2"],
    }

def reference(A_x, A_wqkv, A_wo, B_x, B_w1, B_w2):
    def _A_ref(x, wqkv, wo):
        B, S, D = x.shape
        H = 32; Dh = D // H
        qkv = (lambda x, *d: x.permute(*d))((x @ wqkv).reshape(B, S, 3, H, Dh), 2, 0, 3, 1, 4)
        q, k, v = qkv[0], qkv[1], qkv[2]
        phi = lambda t: torch.where(t > 0, t + 1, torch.exp(t)) + 1e-6
        pq, pk = phi(q), phi(k)
        kv = torch.einsum("bhsd,bhse->bhde", pk, v)
        z = torch.einsum("bhsd->bhd", pk)
        num = torch.einsum("bhqd,bhde->bhqe", pq, kv)
        den = torch.einsum("bhqd,bhd->bhq", pq, z)[..., None] + 1e-6
        o = num / den
        return (lambda x, *d: x.permute(*d))(o, 0, 2, 1, 3).reshape(B, S, D) @ wo

    def _B_ref(x, w1, w2):
        h = torch.einsum("bsd,df->bsf", x, w1)
        h = _silu(h)
        out = torch.einsum("bsf,fd->bsd", h, w2)
        return out

    x = A_x
    x = x + _A_ref(_layernorm(x, axis=-1), A_wqkv, A_wo)
    x = x + _B_ref(_layernorm(x, axis=-1), B_w1, B_w2)
    x = x + _A_ref(_layernorm(x, axis=-1), A_wqkv, A_wo)
    x = x + _B_ref(_layernorm(x, axis=-1), B_w1, B_w2)
    return x
```

```asm
; @launch kernel=interleave_layers__linear_attn_block__dense_activation_silu__prompt_kernel grid=(256,1,1) block=(768,1,1) lds=162816
.amdgcn_target "amdgcn-amd-amdhsa--gfx950"
.text
.globl interleave_layers__linear_attn_block__dense_activation_silu__prompt_kernel
.p2align 8
.type interleave_layers__linear_attn_block__dense_activation_silu__prompt_kernel,@function
interleave_layers__linear_attn_block__dense_activation_silu__prompt_kernel:
    s_cmp_ge_u32 s2, 256
    s_cbranch_scc1 mega_end
    s_load_dwordx2 s[94:95], s[0:1], 48
    s_load_dwordx2 s[52:53], s[0:1], 56
    s_load_dwordx4 s[24:27], s[0:1], 0
    s_load_dwordx4 s[32:35], s[0:1], 32
    s_load_dwordx2 s[28:29], s[0:1], 16
    s_load_dwordx2 s[8:9], s[0:1], 64
    s_mov_b32 s10, 0x10000000
    s_mov_b32 s11, 0x20000
    v_lshrrev_b32 v1, 6, v0
    s_nop 0
    v_readfirstlane_b32 s3, v1
    v_and_b32 v0, 63, v0
    v_lshlrev_b32 v1, 4, v0
    v_and_b32 v2, 15, v0
    v_lshrrev_b32 v3, 4, v0
    s_mov_b32 s15, 0x20000
    s_and_b32 s30, s2, 7
    s_lshr_b32 s31, s2, 3
    s_cmp_ge_u32 s3, 6
    s_cbranch_scc1 prep_hi
    s_mov_b32 s47, 0
    s_mul_i32 s22, s3, 12288
    s_add_u32 s22, s22, 3072
    s_cmp_lt_u32 s2, 48
    s_cbranch_scc1 prep_q
    s_cmp_ge_u32 s2, 192
    s_cbranch_scc1 prep_o
    s_sub_u32 s4, s31, 6
    s_and_b32 s5, s4, 1
    s_lshr_b32 s4, s4, 1
    s_lshl_b32 s4, s4, 3
    s_add_u32 s4, s4, s30
    s_lshl_b32 s21, s4, 1
    s_add_u32 s21, s21, s5
    s_sub_u32 s20, 5, s3
    s_cmp_eq_u32 s5, 1
    s_cselect_b32 s20, s20, s3
    s_mul_i32 s19, s20, 884736
    s_lshl_b32 s4, s21, 6
    s_add_u32 s19, s19, s4
    v_lshrrev_b32 v4, 2, v0
    v_mul_u32_u24 v4, 9152, v4
    v_add_u32 v4, v4, v1
    s_mov_b32 s14, 5308416
    s_waitcnt lgkmcnt(0)
    s_mov_b32 s12, s32
    s_mov_b32 s13, s33
    s_mul_i32 s4, s5, 5120
    s_add_u32 s23, s22, s4
    s_mul_i32 s4, s5, 737280
    s_add_u32 s19, s19, s4
    s_lshl_b32 s4, s5, 1
    s_sub_u32 s4, 1, s4
    s_lshl_b32 s16, s4, 10
    s_mul_i32 s17, s4, 147456
    s_mov_b32 m0, s23
    s_add_u32 s23, s23, s16
    buffer_load_dwordx4 v4, s[12:15], s19 offen nt lds
    s_add_u32 s19, s19, s17
    s_mov_b32 m0, s23
    s_add_u32 s23, s23, s16
    buffer_load_dwordx4 v4, s[12:15], s19 offen nt lds
    s_add_u32 s19, s19, s17
    s_mov_b32 m0, s23
    s_add_u32 s23, s23, s16
    buffer_load_dwordx4 v4, s[12:15], s19 offen nt lds
    s_add_u32 s19, s19, s17
    s_mov_b32 m0, s23
    s_add_u32 s23, s23, s16
    buffer_load_dwordx4 v4, s[12:15], s19 offen nt lds
    s_add_u32 s19, s19, s17
    s_mov_b32 m0, s23
    s_add_u32 s23, s23, s16
    buffer_load_dwordx4 v4, s[12:15], s19 offen nt lds
    s_add_u32 s19, s19, s17
    s_mov_b32 m0, s23
    s_add_u32 s23, s23, s16
    buffer_load_dwordx4 v4, s[12:15], s19 offen nt lds
    s_add_u32 s19, s19, s17
    s_lshl_b32 s4, s21, 1
    s_add_u32 s4, s4, 0
    s_mul_i32 s5, s4, 43691
    s_lshr_b32 s5, s5, 17
    s_mul_i32 s6, s5, 3
    s_sub_u32 s4, s4, s6
    s_and_b32 s6, s5, 1
    s_lshl_b32 s6, s6, 1
    s_add_u32 s4, s4, s6
    s_cmp_ge_u32 s4, 3
    s_cselect_b32 s6, 3, 0
    s_sub_u32 s4, s4, s6
    s_mul_i32 s6, s5, 54
    s_add_u32 s4, s4, s6
    s_mul_i32 s6, s20, 9
    s_add_u32 s4, s4, s6
    s_lshl_b32 s4, s4, 10
    s_add_u32 s36, s4, 2727936
    s_lshl_b32 s4, s21, 1
    s_add_u32 s4, s4, 1
    s_mul_i32 s5, s4, 43691
    s_lshr_b32 s5, s5, 17
    s_mul_i32 s6, s5, 3
    s_sub_u32 s4, s4, s6
    s_and_b32 s6, s5, 1
    s_lshl_b32 s6, s6, 1
    s_add_u32 s4, s4, s6
    s_cmp_ge_u32 s4, 3
    s_cselect_b32 s6, 3, 0
    s_sub_u32 s4, s4, s6
    s_mul_i32 s6, s5, 54
    s_add_u32 s4, s4, s6
    s_mul_i32 s6, s20, 9
    s_add_u32 s4, s4, s6
    s_lshl_b32 s4, s4, 10
    s_add_u32 s37, s4, 2727936
    s_mov_b32 s17, 3072
    s_mov_b32 s18, 4
    s_mov_b32 s19, 8
prep_tr:
    v_lshlrev_b32 v5, 9, v3
    v_and_b32 v6, 12, v0
    v_lshl_add_u32 v5, v6, 4, v5
    v_and_b32 v6, 3, v0
    v_lshl_add_u32 v5, v6, s18, v5
    v_add_u32 v5, s22, v5
    v_add_u32 v6, s19, v5
    s_waitcnt vmcnt(0)
    ds_read_b64_tr_b16 v[24:25], v5 offset:0
    ds_read_b64_tr_b16 v[26:27], v5 offset:256
    ds_read_b64_tr_b16 v[28:29], v6 offset:0
    ds_read_b64_tr_b16 v[30:31], v6 offset:256
    s_waitcnt vmcnt(0)
    ds_read_b64_tr_b16 v[32:33], v5 offset:2048
    ds_read_b64_tr_b16 v[34:35], v5 offset:2304
    ds_read_b64_tr_b16 v[36:37], v6 offset:2048
    ds_read_b64_tr_b16 v[38:39], v6 offset:2304
    s_waitcnt vmcnt(0)
    ds_read_b64_tr_b16 v[40:41], v5 offset:4096
    ds_read_b64_tr_b16 v[42:43], v5 offset:4352
    ds_read_b64_tr_b16 v[44:45], v6 offset:4096
    ds_read_b64_tr_b16 v[46:47], v6 offset:4352
    s_waitcnt lgkmcnt(0)
    s_cmp_ge_u32 s2, 192
    s_cbranch_scc1 prep_st
    v_mov_b32 v8, 0x3f803f80
    v_mov_b32 v9, 0x3f803f80
    v_mov_b32 v10, 0x3f803f80
    v_mov_b32 v11, 0x3f803f80
    s_nop 1
    v_mfma_f32_16x16x32_bf16 v[60:63], v[8:11], v[24:27], 0
    v_mfma_f32_16x16x32_bf16 v[64:67], v[8:11], v[28:31], 0
    v_mfma_f32_16x16x32_bf16 v[60:63], v[8:11], v[32:35], v[60:63]
    v_mfma_f32_16x16x32_bf16 v[64:67], v[8:11], v[36:39], v[64:67]
    v_mfma_f32_16x16x32_bf16 v[60:63], v[8:11], v[40:43], v[60:63]
    v_mfma_f32_16x16x32_bf16 v[64:67], v[8:11], v[44:47], v[64:67]
    v_mul_u32_u24 v4, 96, v2
    s_lshl_b32 s4, s3, 4
    v_add_u32 v5, s4, v4
    s_nop 4
    v_mov_b32 v61, v64
    ds_write_b128 v5, v[60:63] offset:0
    s_waitcnt lgkmcnt(0)
    s_barrier
    ds_read_b128 v[60:63], v4 offset:0
    ds_read_b128 v[64:67], v4 offset:16
    ds_read_b128 v[68:71], v4 offset:32
    ds_read_b128 v[72:75], v4 offset:48
    ds_read_b128 v[76:79], v4 offset:64
    ds_read_b128 v[80:83], v4 offset:80
    s_waitcnt lgkmcnt(0)
    v_add_f32 v60, v60, v64
    v_add_f32 v61, v61, v65
    v_add_f32 v60, v60, v68
    v_add_f32 v61, v61, v69
    v_add_f32 v60, v60, v72
    v_add_f32 v61, v61, v73
    v_add_f32 v60, v60, v76
    v_add_f32 v61, v61, v77
    v_add_f32 v60, v60, v80
    v_add_f32 v61, v61, v81
    v_mul_f32 v68, 0xbae38e39, v60
    v_mul_f32 v70, 0xbae38e39, v61
    v_lshlrev_b32 v12, 16, v24
    v_and_b32 v13, 0xffff0000, v24
    v_lshlrev_b32 v14, 16, v25
    v_and_b32 v15, 0xffff0000, v25
    v_lshlrev_b32 v16, 16, v26
    v_and_b32 v17, 0xffff0000, v26
    v_lshlrev_b32 v18, 16, v27
    v_and_b32 v19, 0xffff0000, v27
    v_pk_add_f32 v[12:13], v[12:13], v[68:69] op_sel_hi:[1,0]
    v_pk_add_f32 v[14:15], v[14:15], v[68:69] op_sel_hi:[1,0]
    v_pk_add_f32 v[16:17], v[16:17], v[68:69] op_sel_hi:[1,0]
    v_pk_add_f32 v[18:19], v[18:19], v[68:69] op_sel_hi:[1,0]
    v_cvt_pk_bf16_f32 v24, v12, v13
    v_cvt_pk_bf16_f32 v25, v14, v15
    v_cvt_pk_bf16_f32 v26, v16, v17
    v_cvt_pk_bf16_f32 v27, v18, v19
    buffer_store_dwordx4 v[24:27], v1, s[8:11], s36 offen sc1
    s_add_u32 s36, s36, s17
    v_lshlrev_b32 v12, 16, v28
    v_and_b32 v13, 0xffff0000, v28
    v_lshlrev_b32 v14, 16, v29
    v_and_b32 v15, 0xffff0000, v29
    v_lshlrev_b32 v16, 16, v30
    v_and_b32 v17, 0xffff0000, v30
    v_lshlrev_b32 v18, 16, v31
    v_and_b32 v19, 0xffff0000, v31
    v_pk_add_f32 v[12:13], v[12:13], v[70:71] op_sel_hi:[1,0]
    v_pk_add_f32 v[14:15], v[14:15], v[70:71] op_sel_hi:[1,0]
    v_pk_add_f32 v[16:17], v[16:17], v[70:71] op_sel_hi:[1,0]
    v_pk_add_f32 v[18:19], v[18:19], v[70:71] op_sel_hi:[1,0]
    v_cvt_pk_bf16_f32 v28, v12, v13
    v_cvt_pk_bf16_f32 v29, v14, v15
    v_cvt_pk_bf16_f32 v30, v16, v17
    v_cvt_pk_bf16_f32 v31, v18, v19
    buffer_store_dwordx4 v[28:31], v1, s[8:11], s37 offen sc1
    s_add_u32 s37, s37, s17
    v_lshlrev_b32 v12, 16, v32
    v_and_b32 v13, 0xffff0000, v32
    v_lshlrev_b32 v14, 16, v33
    v_and_b32 v15, 0xffff0000, v33
    v_lshlrev_b32 v16, 16, v34
    v_and_b32 v17, 0xffff0000, v34
    v_lshlrev_b32 v18, 16, v35
    v_and_b32 v19, 0xffff0000, v35
    v_pk_add_f32 v[12:13], v[12:13], v[68:69] op_sel_hi:[1,0]
    v_pk_add_f32 v[14:15], v[14:15], v[68:69] op_sel_hi:[1,0]
    v_pk_add_f32 v[16:17], v[16:17], v[68:69] op_sel_hi:[1,0]
    v_pk_add_f32 v[18:19], v[18:19], v[68:69] op_sel_hi:[1,0]
    v_cvt_pk_bf16_f32 v32, v12, v13
    v_cvt_pk_bf16_f32 v33, v14, v15
    v_cvt_pk_bf16_f32 v34, v16, v17
    v_cvt_pk_bf16_f32 v35, v18, v19
    buffer_store_dwordx4 v[32:35], v1, s[8:11], s36 offen sc1
    s_add_u32 s36, s36, s17
    v_lshlrev_b32 v12, 16, v36
    v_and_b32 v13, 0xffff0000, v36
    v_lshlrev_b32 v14, 16, v37
    v_and_b32 v15, 0xffff0000, v37
    v_lshlrev_b32 v16, 16, v38
    v_and_b32 v17, 0xffff0000, v38
    v_lshlrev_b32 v18, 16, v39
    v_and_b32 v19, 0xffff0000, v39
    v_pk_add_f32 v[12:13], v[12:13], v[70:71] op_sel_hi:[1,0]
    v_pk_add_f32 v[14:15], v[14:15], v[70:71] op_sel_hi:[1,0]
    v_pk_add_f32 v[16:17], v[16:17], v[70:71] op_sel_hi:[1,0]
    v_pk_add_f32 v[18:19], v[18:19], v[70:71] op_sel_hi:[1,0]
    v_cvt_pk_bf16_f32 v36, v12, v13
    v_cvt_pk_bf16_f32 v37, v14, v15
    v_cvt_pk_bf16_f32 v38, v16, v17
    v_cvt_pk_bf16_f32 v39, v18, v19
    buffer_store_dwordx4 v[36:39], v1, s[8:11], s37 offen sc1
    s_add_u32 s37, s37, s17
    v_lshlrev_b32 v12, 16, v40
    v_and_b32 v13, 0xffff0000, v40
    v_lshlrev_b32 v14, 16, v41
    v_and_b32 v15, 0xffff0000, v41
    v_lshlrev_b32 v16, 16, v42
    v_and_b32 v17, 0xffff0000, v42
    v_lshlrev_b32 v18, 16, v43
    v_and_b32 v19, 0xffff0000, v43
    v_pk_add_f32 v[12:13], v[12:13], v[68:69] op_sel_hi:[1,0]
    v_pk_add_f32 v[14:15], v[14:15], v[68:69] op_sel_hi:[1,0]
    v_pk_add_f32 v[16:17], v[16:17], v[68:69] op_sel_hi:[1,0]
    v_pk_add_f32 v[18:19], v[18:19], v[68:69] op_sel_hi:[1,0]
    v_cvt_pk_bf16_f32 v40, v12, v13
    v_cvt_pk_bf16_f32 v41, v14, v15
    v_cvt_pk_bf16_f32 v42, v16, v17
    v_cvt_pk_bf16_f32 v43, v18, v19
    buffer_store_dwordx4 v[40:43], v1, s[8:11], s36 offen sc1
    s_add_u32 s36, s36, s17
    v_lshlrev_b32 v12, 16, v44
    v_and_b32 v13, 0xffff0000, v44
    v_lshlrev_b32 v14, 16, v45
    v_and_b32 v15, 0xffff0000, v45
    v_lshlrev_b32 v16, 16, v46
    v_and_b32 v17, 0xffff0000, v46
    v_lshlrev_b32 v18, 16, v47
    v_and_b32 v19, 0xffff0000, v47
    v_pk_add_f32 v[12:13], v[12:13], v[70:71] op_sel_hi:[1,0]
    v_pk_add_f32 v[14:15], v[14:15], v[70:71] op_sel_hi:[1,0]
    v_pk_add_f32 v[16:17], v[16:17], v[70:71] op_sel_hi:[1,0]
    v_pk_add_f32 v[18:19], v[18:19], v[70:71] op_sel_hi:[1,0]
    v_cvt_pk_bf16_f32 v44, v12, v13
    v_cvt_pk_bf16_f32 v45, v14, v15
    v_cvt_pk_bf16_f32 v46, v16, v17
    v_cvt_pk_bf16_f32 v47, v18, v19
    buffer_store_dwordx4 v[44:47], v1, s[8:11], s37 offen sc1
    s_add_u32 s37, s37, s17
    s_branch prep_join
prep_q:
    s_and_b32 s21, s31, 1
    s_lshr_b32 s31, s31, 1
    s_lshl_b32 s4, s30, 1
    s_add_u32 s4, s4, s21
    s_mul_i32 s4, s4, 72
    s_and_b32 s20, s4, 63
    s_sub_u32 s4, s4, s20
    s_mul_i32 s19, s3, 331776
    s_add_u32 s19, s19, s4
    s_mul_i32 s4, s31, 1152
    s_add_u32 s19, s19, s4
    v_lshrrev_b32 v4, 3, v0
    v_mul_u32_u24 v4, 3328, v4
    v_add_u32 v4, v4, v1
    s_mov_b32 s14, 1990656
    s_waitcnt lgkmcnt(0)
    s_mov_b32 s12, s26
    s_mov_b32 s13, s27
    s_add_u32 m0, s22, 0
    s_add_u32 s4, s19, 0
    buffer_load_dwordx4 v4, s[12:15], s4 offen lds
    s_add_u32 m0, s22, 1024
    s_add_u32 s4, s19, 27648
    buffer_load_dwordx4 v4, s[12:15], s4 offen lds
    s_add_u32 m0, s22, 2048
    s_add_u32 s4, s19, 55296
    buffer_load_dwordx4 v4, s[12:15], s4 offen lds
    s_add_u32 m0, s22, 3072
    s_add_u32 s4, s19, 82944
    buffer_load_dwordx4 v4, s[12:15], s4 offen lds
    s_add_u32 m0, s22, 4096
    s_add_u32 s4, s19, 110592
    buffer_load_dwordx4 v4, s[12:15], s4 offen lds
    s_add_u32 m0, s22, 5120
    s_add_u32 s4, s19, 138240
    buffer_load_dwordx4 v4, s[12:15], s4 offen lds
    s_add_u32 m0, s22, 6144
    s_add_u32 s4, s19, 165888
    buffer_load_dwordx4 v4, s[12:15], s4 offen lds
    s_add_u32 m0, s22, 7168
    s_add_u32 s4, s19, 193536
    buffer_load_dwordx4 v4, s[12:15], s4 offen lds
    s_add_u32 m0, s22, 8192
    s_add_u32 s4, s19, 221184
    buffer_load_dwordx4 v4, s[12:15], s4 offen lds
    s_add_u32 m0, s22, 9216
    s_add_u32 s4, s19, 248832
    buffer_load_dwordx4 v4, s[12:15], s4 offen lds
    s_add_u32 m0, s22, 10240
    s_add_u32 s4, s19, 276480
    buffer_load_dwordx4 v4, s[12:15], s4 offen lds
    s_add_u32 m0, s22, 11264
    s_add_u32 s4, s19, 304128
    buffer_load_dwordx4 v4, s[12:15], s4 offen lds
    v_bfe_u32 v6, v0, 2, 2
    v_lshl_add_u32 v6, v3, 3, v6
    s_add_u32 s22, s22, s20
    v_lshl_add_u32 v6, v6, 7, s22
    v_and_b32 v5, 3, v0
    v_lshl_add_u32 v5, v5, 3, v6
    s_mul_i32 s16, s30, 252
    s_mul_i32 s4, s3, 6
    s_add_u32 s16, s16, s4
    s_lshr_b32 s5, s31, 1
    s_lshl_b32 s6, s21, 1
    s_add_u32 s6, s6, 8
    s_lshl_b32 s7, s21, 2
    s_add_u32 s7, s7, s5
    s_lshl_b32 s18, s5, 1
    s_add_u32 s18, s18, s21
    s_lshl_b32 s18, s18, 2
    s_lshl_b32 s23, s21, 3
    s_cmp_eq_u32 s31, 0
    s_cselect_b32 s36, s6, s7
    s_cselect_b32 s37, 1, 2
    s_cselect_b32 s38, 13, 12
    s_cselect_b32 s42, 0x00ff00ff, 0
    s_cselect_b32 s43, 0, 0x000f000f
    s_cselect_b32 s18, s23, s18
    s_or_b32 s42, s42, s43
    s_lshl_b32 s42, s42, s18
    s_add_u32 s37, s37, s36
    s_lshr_b32 s4, s36, 1
    s_mul_i32 s4, s4, 34
    s_add_u32 s4, s4, s36
    s_add_u32 s4, s4, s16
    s_lshl_b32 s4, s4, 10
    s_add_u32 s36, s4, 0
    s_lshr_b32 s4, s37, 1
    s_mul_i32 s4, s4, 34
    s_add_u32 s4, s4, s37
    s_add_u32 s4, s4, s16
    s_lshl_b32 s4, s4, 10
    s_add_u32 s37, s4, 0
    s_lshr_b32 s4, s38, 1
    s_mul_i32 s4, s4, 34
    s_add_u32 s4, s4, s38
    s_add_u32 s4, s4, s16
    s_lshl_b32 s4, s4, 10
    s_add_u32 s38, s4, 0
    s_waitcnt vmcnt(8)
    ds_read_b64_tr_b16 v[24:25], v5 offset:0
    ds_read_b64_tr_b16 v[26:27], v5 offset:512
    ds_read_b64_tr_b16 v[28:29], v5 offset:40
    ds_read_b64_tr_b16 v[30:31], v5 offset:552
    ds_read_b64_tr_b16 v[32:33], v6 offset:32
    ds_read_b64_tr_b16 v[34:35], v6 offset:544
    s_waitcnt lgkmcnt(6)
    s_waitcnt vmcnt(4)
    ds_read_b64_tr_b16 v[36:37], v5 offset:4096
    ds_read_b64_tr_b16 v[38:39], v5 offset:4608
    ds_read_b64_tr_b16 v[40:41], v5 offset:4136
    ds_read_b64_tr_b16 v[42:43], v5 offset:4648
    ds_read_b64_tr_b16 v[44:45], v6 offset:4128
    ds_read_b64_tr_b16 v[46:47], v6 offset:4640
    s_waitcnt lgkmcnt(6)
    s_waitcnt vmcnt(0)
    ds_read_b64_tr_b16 v[48:49], v5 offset:8192
    ds_read_b64_tr_b16 v[50:51], v5 offset:8704
    ds_read_b64_tr_b16 v[52:53], v5 offset:8232
    ds_read_b64_tr_b16 v[54:55], v5 offset:8744
    ds_read_b64_tr_b16 v[56:57], v6 offset:8224
    ds_read_b64_tr_b16 v[58:59], v6 offset:8736
    s_waitcnt lgkmcnt(0)
    v_mov_b32 v8, 0x3f803f80
    v_mov_b32 v9, 0x3f803f80
    v_mov_b32 v10, 0x3f803f80
    v_mov_b32 v11, 0x3f803f80
    s_nop 1
    v_mfma_f32_16x16x32_bf16 v[60:63], v[8:11], v[24:27], 0
    v_mfma_f32_16x16x32_bf16 v[64:67], v[8:11], v[28:31], 0
    v_mfma_f32_16x16x32_bf16 v[68:71], v[8:11], v[32:35], 0
    v_mfma_f32_16x16x32_bf16 v[60:63], v[8:11], v[36:39], v[60:63]
    v_mfma_f32_16x16x32_bf16 v[64:67], v[8:11], v[40:43], v[64:67]
    v_mfma_f32_16x16x32_bf16 v[68:71], v[8:11], v[44:47], v[68:71]
    v_mfma_f32_16x16x32_bf16 v[60:63], v[8:11], v[48:51], v[60:63]
    v_mfma_f32_16x16x32_bf16 v[64:67], v[8:11], v[52:55], v[64:67]
    v_mfma_f32_16x16x32_bf16 v[68:71], v[8:11], v[56:59], v[68:71]
    v_mul_u32_u24 v4, 96, v2
    s_lshl_b32 s4, s3, 4
    v_add_u32 v5, s4, v4
    s_nop 3
    v_mov_b32 v61, v64
    v_mov_b32 v62, v68
    ds_write_b128 v5, v[60:63] offset:0
    s_waitcnt lgkmcnt(0)
    s_barrier
    ds_read_b128 v[60:63], v4 offset:0
    ds_read_b128 v[64:67], v4 offset:16
    ds_read_b128 v[68:71], v4 offset:32
    ds_read_b128 v[72:75], v4 offset:48
    ds_read_b128 v[76:79], v4 offset:64
    ds_read_b128 v[80:83], v4 offset:80
    s_waitcnt lgkmcnt(0)
    v_add_f32 v60, v60, v64
    v_add_f32 v61, v61, v65
    v_add_f32 v62, v62, v66
    v_add_f32 v60, v60, v68
    v_add_f32 v61, v61, v69
    v_add_f32 v62, v62, v70
    v_add_f32 v60, v60, v72
    v_add_f32 v61, v61, v73
    v_add_f32 v62, v62, v74
    v_add_f32 v60, v60, v76
    v_add_f32 v61, v61, v77
    v_add_f32 v62, v62, v78
    v_add_f32 v60, v60, v80
    v_add_f32 v61, v61, v81
    v_add_f32 v62, v62, v82
    v_mul_f32 v68, 0xbae38e39, v60
    v_mul_f32 v70, 0xbae38e39, v61
    v_mul_f32 v72, 0xbae38e39, v62
    v_lshlrev_b32 v12, 16, v24
    v_and_b32 v13, 0xffff0000, v24
    v_lshlrev_b32 v14, 16, v25
    v_and_b32 v15, 0xffff0000, v25
    v_lshlrev_b32 v16, 16, v26
    v_and_b32 v17, 0xffff0000, v26
    v_lshlrev_b32 v18, 16, v27
    v_and_b32 v19, 0xffff0000, v27
    v_pk_add_f32 v[12:13], v[12:13], v[68:69] op_sel_hi:[1,0]
    v_pk_add_f32 v[14:15], v[14:15], v[68:69] op_sel_hi:[1,0]
    v_pk_add_f32 v[16:17], v[16:17], v[68:69] op_sel_hi:[1,0]
    v_pk_add_f32 v[18:19], v[18:19], v[68:69] op_sel_hi:[1,0]
    v_cvt_pk_bf16_f32 v24, v12, v13
    v_cvt_pk_bf16_f32 v25, v14, v15
    v_cvt_pk_bf16_f32 v26, v16, v17
    v_cvt_pk_bf16_f32 v27, v18, v19
    buffer_store_dwordx4 v[24:27], v1, s[8:11], s36 offen offset:0 sc1
    v_lshlrev_b32 v12, 16, v28
    v_and_b32 v13, 0xffff0000, v28
    v_lshlrev_b32 v14, 16, v29
    v_and_b32 v15, 0xffff0000, v29
    v_lshlrev_b32 v16, 16, v30
    v_and_b32 v17, 0xffff0000, v30
    v_lshlrev_b32 v18, 16, v31
    v_and_b32 v19, 0xffff0000, v31
    v_pk_add_f32 v[12:13], v[12:13], v[70:71] op_sel_hi:[1,0]
    v_pk_add_f32 v[14:15], v[14:15], v[70:71] op_sel_hi:[1,0]
    v_pk_add_f32 v[16:17], v[16:17], v[70:71] op_sel_hi:[1,0]
    v_pk_add_f32 v[18:19], v[18:19], v[70:71] op_sel_hi:[1,0]
    v_cvt_pk_bf16_f32 v28, v12, v13
    v_cvt_pk_bf16_f32 v29, v14, v15
    v_cvt_pk_bf16_f32 v30, v16, v17
    v_cvt_pk_bf16_f32 v31, v18, v19
    buffer_store_dwordx4 v[28:31], v1, s[8:11], s37 offen offset:0 sc1
    v_lshlrev_b32 v12, 16, v32
    v_and_b32 v13, 0xffff0000, v32
    v_lshlrev_b32 v14, 16, v33
    v_and_b32 v15, 0xffff0000, v33
    v_lshlrev_b32 v16, 16, v34
    v_and_b32 v17, 0xffff0000, v34
    v_lshlrev_b32 v18, 16, v35
    v_and_b32 v19, 0xffff0000, v35
    v_pk_add_f32 v[12:13], v[12:13], v[72:73] op_sel_hi:[1,0]
    v_pk_add_f32 v[14:15], v[14:15], v[72:73] op_sel_hi:[1,0]
    v_pk_add_f32 v[16:17], v[16:17], v[72:73] op_sel_hi:[1,0]
    v_pk_add_f32 v[18:19], v[18:19], v[72:73] op_sel_hi:[1,0]
    v_cvt_pk_bf16_f32 v32, v12, v13
    v_cvt_pk_bf16_f32 v33, v14, v15
    v_cvt_pk_bf16_f32 v34, v16, v17
    v_cvt_pk_bf16_f32 v35, v18, v19
    s_mov_b32 exec_lo, s42
    s_mov_b32 exec_hi, s42
    buffer_store_dwordx4 v[32:35], v1, s[8:11], s38 offen offset:0 sc1
    s_mov_b64 exec, -1
    v_lshlrev_b32 v12, 16, v36
    v_and_b32 v13, 0xffff0000, v36
    v_lshlrev_b32 v14, 16, v37
    v_and_b32 v15, 0xffff0000, v37
    v_lshlrev_b32 v16, 16, v38
    v_and_b32 v17, 0xffff0000, v38
    v_lshlrev_b32 v18, 16, v39
    v_and_b32 v19, 0xffff0000, v39
    v_pk_add_f32 v[12:13], v[12:13], v[68:69] op_sel_hi:[1,0]
    v_pk_add_f32 v[14:15], v[14:15], v[68:69] op_sel_hi:[1,0]
    v_pk_add_f32 v[16:17], v[16:17], v[68:69] op_sel_hi:[1,0]
    v_pk_add_f32 v[18:19], v[18:19], v[68:69] op_sel_hi:[1,0]
    v_cvt_pk_bf16_f32 v36, v12, v13
    v_cvt_pk_bf16_f32 v37, v14, v15
    v_cvt_pk_bf16_f32 v38, v16, v17
    v_cvt_pk_bf16_f32 v39, v18, v19
    buffer_store_dwordx4 v[36:39], v1, s[8:11], s36 offen offset:2048 sc1
    s_add_u32 s36, s36, 4096
    v_lshlrev_b32 v12, 16, v40
    v_and_b32 v13, 0xffff0000, v40
    v_lshlrev_b32 v14, 16, v41
    v_and_b32 v15, 0xffff0000, v41
    v_lshlrev_b32 v16, 16, v42
    v_and_b32 v17, 0xffff0000, v42
    v_lshlrev_b32 v18, 16, v43
    v_and_b32 v19, 0xffff0000, v43
    v_pk_add_f32 v[12:13], v[12:13], v[70:71] op_sel_hi:[1,0]
    v_pk_add_f32 v[14:15], v[14:15], v[70:71] op_sel_hi:[1,0]
    v_pk_add_f32 v[16:17], v[16:17], v[70:71] op_sel_hi:[1,0]
    v_pk_add_f32 v[18:19], v[18:19], v[70:71] op_sel_hi:[1,0]
    v_cvt_pk_bf16_f32 v40, v12, v13
    v_cvt_pk_bf16_f32 v41, v14, v15
    v_cvt_pk_bf16_f32 v42, v16, v17
    v_cvt_pk_bf16_f32 v43, v18, v19
    buffer_store_dwordx4 v[40:43], v1, s[8:11], s37 offen offset:2048 sc1
    s_add_u32 s37, s37, 4096
    v_lshlrev_b32 v12, 16, v44
    v_and_b32 v13, 0xffff0000, v44
    v_lshlrev_b32 v14, 16, v45
    v_and_b32 v15, 0xffff0000, v45
    v_lshlrev_b32 v16, 16, v46
    v_and_b32 v17, 0xffff0000, v46
    v_lshlrev_b32 v18, 16, v47
    v_and_b32 v19, 0xffff0000, v47
    v_pk_add_f32 v[12:13], v[12:13], v[72:73] op_sel_hi:[1,0]
    v_pk_add_f32 v[14:15], v[14:15], v[72:73] op_sel_hi:[1,0]
    v_pk_add_f32 v[16:17], v[16:17], v[72:73] op_sel_hi:[1,0]
    v_pk_add_f32 v[18:19], v[18:19], v[72:73] op_sel_hi:[1,0]
    v_cvt_pk_bf16_f32 v44, v12, v13
    v_cvt_pk_bf16_f32 v45, v14, v15
    v_cvt_pk_bf16_f32 v46, v16, v17
    v_cvt_pk_bf16_f32 v47, v18, v19
    s_mov_b32 exec_lo, s42
    s_mov_b32 exec_hi, s42
    buffer_store_dwordx4 v[44:47], v1, s[8:11], s38 offen offset:2048 sc1
    s_mov_b64 exec, -1
    s_add_u32 s38, s38, 4096
    v_lshlrev_b32 v12, 16, v48
    v_and_b32 v13, 0xffff0000, v48
    v_lshlrev_b32 v14, 16, v49
    v_and_b32 v15, 0xffff0000, v49
    v_lshlrev_b32 v16, 16, v50
    v_and_b32 v17, 0xffff0000, v50
    v_lshlrev_b32 v18, 16, v51
    v_and_b32 v19, 0xffff0000, v51
    v_pk_add_f32 v[12:13], v[12:13], v[68:69] op_sel_hi:[1,0]
    v_pk_add_f32 v[14:15], v[14:15], v[68:69] op_sel_hi:[1,0]
    v_pk_add_f32 v[16:17], v[16:17], v[68:69] op_sel_hi:[1,0]
    v_pk_add_f32 v[18:19], v[18:19], v[68:69] op_sel_hi:[1,0]
    v_cvt_pk_bf16_f32 v48, v12, v13
    v_cvt_pk_bf16_f32 v49, v14, v15
    v_cvt_pk_bf16_f32 v50, v16, v17
    v_cvt_pk_bf16_f32 v51, v18, v19
    buffer_store_dwordx4 v[48:51], v1, s[8:11], s36 offen offset:0 sc1
    v_lshlrev_b32 v12, 16, v52
    v_and_b32 v13, 0xffff0000, v52
    v_lshlrev_b32 v14, 16, v53
    v_and_b32 v15, 0xffff0000, v53
    v_lshlrev_b32 v16, 16, v54
    v_and_b32 v17, 0xffff0000, v54
    v_lshlrev_b32 v18, 16, v55
    v_and_b32 v19, 0xffff0000, v55
    v_pk_add_f32 v[12:13], v[12:13], v[70:71] op_sel_hi:[1,0]
    v_pk_add_f32 v[14:15], v[14:15], v[70:71] op_sel_hi:[1,0]
    v_pk_add_f32 v[16:17], v[16:17], v[70:71] op_sel_hi:[1,0]
    v_pk_add_f32 v[18:19], v[18:19], v[70:71] op_sel_hi:[1,0]
    v_cvt_pk_bf16_f32 v52, v12, v13
    v_cvt_pk_bf16_f32 v53, v14, v15
    v_cvt_pk_bf16_f32 v54, v16, v17
    v_cvt_pk_bf16_f32 v55, v18, v19
    buffer_store_dwordx4 v[52:55], v1, s[8:11], s37 offen offset:0 sc1
    v_lshlrev_b32 v12, 16, v56
    v_and_b32 v13, 0xffff0000, v56
    v_lshlrev_b32 v14, 16, v57
    v_and_b32 v15, 0xffff0000, v57
    v_lshlrev_b32 v16, 16, v58
    v_and_b32 v17, 0xffff0000, v58
    v_lshlrev_b32 v18, 16, v59
    v_and_b32 v19, 0xffff0000, v59
    v_pk_add_f32 v[12:13], v[12:13], v[72:73] op_sel_hi:[1,0]
    v_pk_add_f32 v[14:15], v[14:15], v[72:73] op_sel_hi:[1,0]
    v_pk_add_f32 v[16:17], v[16:17], v[72:73] op_sel_hi:[1,0]
    v_pk_add_f32 v[18:19], v[18:19], v[72:73] op_sel_hi:[1,0]
    v_cvt_pk_bf16_f32 v56, v12, v13
    v_cvt_pk_bf16_f32 v57, v14, v15
    v_cvt_pk_bf16_f32 v58, v16, v17
    v_cvt_pk_bf16_f32 v59, v18, v19
    s_mov_b32 exec_lo, s42
    s_mov_b32 exec_hi, s42
    buffer_store_dwordx4 v[56:59], v1, s[8:11], s38 offen offset:0 sc1
    s_mov_b64 exec, -1
    s_branch prep_join
prep_hi:
    s_mov_b32 s47, 1
    s_cmp_ge_u32 s3, 8
    s_cbranch_scc1 prep_i8
    s_lshl_b32 s31, s31, 1
    s_add_u32 s31, s31, s3
    s_sub_u32 s31, s31, 18
    s_cmp_ge_u32 s31, 51
    s_cbranch_scc1 prep_bar
    s_setprio 3
    s_mul_i32 s5, s31, 3856
    s_lshr_b32 s5, s5, 16
    s_mul_i32 s6, s5, 17
    s_sub_u32 s4, s31, s6
    s_add_u32 s4, s4, 1
    s_mul_i32 s19, s4, 110592
    s_mul_i32 s5, s5, 1152
    s_add_u32 s19, s19, s5
    s_lshl_b32 s5, s30, 7
    s_add_u32 s19, s19, s5
    v_lshrrev_b32 v4, 1, v0
    v_mul_u32_u24 v4, 3456, v4
    v_and_b32 v6, 1, v0
    v_lshl_add_u32 v4, v6, 7, v4
    s_mov_b32 s14, 1990656
    s_waitcnt lgkmcnt(0)
    s_mov_b32 s12, s26
    s_mov_b32 s13, s27
    buffer_load_dword v22, v4, s[12:15], s19 offen
    s_setprio 0
    s_branch prep_bar
prep_i8:
    s_cmp_eq_u32 s3, 11
    s_cbranch_scc1 prep_i11
    s_cmp_eq_u32 s3, 8
    s_cbranch_scc0 prep_bar
    s_getpc_b64 s[4:5]
prep_pc:
    s_sub_u32 s4, s4, prep_pc-interleave_layers__linear_attn_block__dense_activation_silu__prompt_kernel
    s_subb_u32 s5, s5, 0
    s_mul_i32 s6, s31, 1536
    v_lshl_add_u32 v4, v0, 7, s6
    v_min_u32 v4, code_end-interleave_layers__linear_attn_block__dense_activation_silu__prompt_kernel-4, v4
    s_mov_b64 exec, 0xfff
    global_load_dword v20, v4, s[4:5]
    s_mov_b64 exec, -1
    s_branch prep_bar
prep_o:
    s_cmp_ge_u32 s2, 216
    s_cbranch_scc1 prep_x
    s_cmp_ge_u32 s2, 210
    s_cbranch_scc1 prep_z
    s_sub_u32 s21, s2, 192
    s_lshl_b32 s4, s30, 1
    s_lshr_b32 s5, s21, 3
    s_add_u32 s4, s4, s5
    s_cmp_lt_u32 s21, 16
    s_cselect_b32 s21, s4, s21
    s_sub_u32 s23, 5, s3
    s_and_b32 s4, s21, 1
    s_cselect_b32 s23, s23, s3
    v_bfe_u32 v8, v0, 2, 3
    v_lshrrev_b32 v7, 5, v0
    v_and_b32 v9, 3, v0
    v_lshlrev_b32 v9, 4, v9
    v_lshrrev_b32 v10, 2, v8
    v_and_b32 v11, 3, v8
    v_mad_u32_u24 v10, v10, 20, v11
    v_lshl_add_u32 v10, v7, 2, v10
    v_mul_u32_u24 v10, 1152, v10
    v_add_u32 v10, v10, v9
    v_lshrrev_b32 v11, 1, v8
    v_mul_u32_u24 v11, 72, v11
    v_and_b32 v4, 1, v8
    v_add_u32 v11, v11, v4
    v_lshl_add_u32 v11, v7, 1, v11
    v_mul_u32_u24 v11, 1152, v11
    v_add_u32 v11, v11, v9
    s_mov_b32 s14, 663552
    s_lshl_b32 s18, s21, 6
    s_waitcnt lgkmcnt(0)
    s_mov_b32 s12, s28
    s_mov_b32 s13, s29
    s_mul_i32 s4, s23, 3
    s_add_u32 s4, s4, 0
    s_mul_i32 s19, s4, 36
    s_sub_u32 s5, s4, 16
    s_mul_i32 s5, s5, 288
    s_add_u32 s5, s5, 16
    s_cmp_lt_u32 s4, 16
    s_cselect_b32 s19, s19, s5
    s_cselect_b32 s20, 8, 36
    s_cselect_b64 vcc, -1, 0
    s_mul_i32 s19, s19, 1152
    s_add_u32 s19, s19, s18
    s_mul_i32 s20, s20, 1152
    s_add_u32 s20, s20, s19
    v_cndmask_b32 v4, v11, v10, vcc
    s_add_u32 m0, s22, 0
    s_nop 0
    buffer_load_dwordx4 v4, s[12:15], s19 offen nt lds
    s_add_u32 m0, s22, 1024
    s_nop 0
    buffer_load_dwordx4 v4, s[12:15], s20 offen nt lds
    s_mul_i32 s4, s23, 3
    s_add_u32 s4, s4, 1
    s_mul_i32 s19, s4, 36
    s_sub_u32 s5, s4, 16
    s_mul_i32 s5, s5, 288
    s_add_u32 s5, s5, 16
    s_cmp_lt_u32 s4, 16
    s_cselect_b32 s19, s19, s5
    s_cselect_b32 s20, 8, 36
    s_cselect_b64 vcc, -1, 0
    s_mul_i32 s19, s19, 1152
    s_add_u32 s19, s19, s18
    s_mul_i32 s20, s20, 1152
    s_add_u32 s20, s20, s19
    v_cndmask_b32 v4, v11, v10, vcc
    s_add_u32 m0, s22, 2048
    s_nop 0
    buffer_load_dwordx4 v4, s[12:15], s19 offen nt lds
    s_add_u32 m0, s22, 3072
    s_nop 0
    buffer_load_dwordx4 v4, s[12:15], s20 offen nt lds
    s_mul_i32 s4, s23, 3
    s_add_u32 s4, s4, 2
    s_mul_i32 s19, s4, 36
    s_sub_u32 s5, s4, 16
    s_mul_i32 s5, s5, 288
    s_add_u32 s5, s5, 16
    s_cmp_lt_u32 s4, 16
    s_cselect_b32 s19, s19, s5
    s_cselect_b32 s20, 8, 36
    s_cselect_b64 vcc, -1, 0
    s_mul_i32 s19, s19, 1152
    s_add_u32 s19, s19, s18
    s_mul_i32 s20, s20, 1152
    s_add_u32 s20, s20, s19
    v_cndmask_b32 v4, v11, v10, vcc
    s_add_u32 m0, s22, 4096
    s_nop 0
    buffer_load_dwordx4 v4, s[12:15], s19 offen nt lds
    s_add_u32 m0, s22, 5120
    s_nop 0
    buffer_load_dwordx4 v4, s[12:15], s20 offen nt lds
    s_lshl_b32 s4, s21, 1
    s_add_u32 s4, s4, 0
    s_mul_i32 s4, s4, 18
    s_mul_i32 s5, s23, 3
    s_add_u32 s4, s4, s5
    s_lshl_b32 s4, s4, 10
    s_add_u32 s36, s4, 2064384
    s_lshl_b32 s4, s21, 1
    s_add_u32 s4, s4, 1
    s_mul_i32 s4, s4, 18
    s_mul_i32 s5, s23, 3
    s_add_u32 s4, s4, s5
    s_lshl_b32 s4, s4, 10
    s_add_u32 s37, s4, 2064384
    s_mov_b32 s17, 1024
    s_lshr_b32 s4, 0x2010, s21
    s_and_b32 s4, s4, 1
    s_cselect_b32 s18, 3, 4
    s_cselect_b32 s19, 32, 8
    s_branch prep_tr
prep_st:
    buffer_store_dwordx4 v[24:27], v1, s[8:11], s36 offen sc1
    s_add_u32 s36, s36, s17
    buffer_store_dwordx4 v[28:31], v1, s[8:11], s37 offen sc1
    s_add_u32 s37, s37, s17
    buffer_store_dwordx4 v[32:35], v1, s[8:11], s36 offen sc1
    s_add_u32 s36, s36, s17
    buffer_store_dwordx4 v[36:39], v1, s[8:11], s37 offen sc1
    s_add_u32 s37, s37, s17
    buffer_store_dwordx4 v[40:43], v1, s[8:11], s36 offen sc1
    s_add_u32 s36, s36, s17
    buffer_store_dwordx4 v[44:47], v1, s[8:11], s37 offen sc1
    s_add_u32 s37, s37, s17
    s_branch prep_bar
prep_z:
    s_sub_u32 s16, s2, 210
    s_mul_i32 s16, s16, 6
    s_add_u32 s16, s16, s3
    s_mul_i32 s16, s16, 6144
    s_add_u32 s16, s16, 27500544
    v_mov_b32 v16, 0
    v_mov_b32 v17, 0
    v_mov_b32 v18, 0
    v_mov_b32 v19, 0
    s_waitcnt lgkmcnt(0)
    buffer_store_dwordx4 v[16:19], v1, s[8:11], s16 offen offset:0 sc1
    buffer_store_dwordx4 v[16:19], v1, s[8:11], s16 offen offset:1024 sc1
    buffer_store_dwordx4 v[16:19], v1, s[8:11], s16 offen offset:2048 sc1
    buffer_store_dwordx4 v[16:19], v1, s[8:11], s16 offen offset:3072 sc1
    s_add_u32 s16, s16, 4096
    buffer_store_dwordx4 v[16:19], v1, s[8:11], s16 offen offset:0 sc1
    buffer_store_dwordx4 v[16:19], v1, s[8:11], s16 offen offset:1024 sc1
    s_branch prep_bar
prep_x:
    s_mov_b32 s47, 1
    s_sub_u32 s4, s31, 27
    s_mul_i32 s4, s4, 6
    s_add_u32 s4, s4, s3
    s_mul_i32 s4, s4, 78
    s_mul_i32 s19, s30, 2304
    s_add_u32 s19, s19, s4
    s_lshl_b32 s19, s19, 7
    s_add_u32 s18, s19, 4992
    v_lshlrev_b32 v4, 7, v0
    s_mov_b32 s14, 2359296
    s_mov_b32 exec_hi, 0x7f
    s_waitcnt lgkmcnt(0)
    s_mov_b32 s12, s24
    s_mov_b32 s13, s25
    buffer_load_dword v20, v4, s[12:15], s19 offen
    buffer_load_dword v21, v4, s[12:15], s18 offen
    s_mov_b32 exec_hi, -1
    s_branch prep_bar
prep_i11:
    s_and_b32 s4, s2, 7
    s_lshr_b32 s5, s2, 3
    s_and_b32 s6, s4, 1
    s_lshl_b32 s6, s6, 2
    s_and_b32 s7, s5, 3
    s_add_u32 s13, s6, s7
    s_lshr_b32 s6, s4, 1
    s_mul_i32 s6, s6, 8
    s_lshr_b32 s7, s5, 2
    s_add_u32 s14, s6, s7
    s_lshl_b32 s51, s14, 7
    s_lshl_b32 s4, s13, 2
    s_add_u32 s51, s51, s4
    s_add_u32 s51, s51, 27721728
    s_mov_b32 s6, 0
    s_waitcnt lgkmcnt(0)
    s_atomic_swap s6, s[8:9], s51 glc
prep_bar:
    s_barrier
prep_join:
    s_waitcnt lgkmcnt(0)
    s_mov_b32 s12, s3
    s_mov_b32 s36, s24
    s_mov_b32 s37, s25
    s_mov_b32 s100, s34
    s_mov_b32 s101, s35
    s_mov_b32 s38, 2359296
    s_mov_b32 s39, 0x20000
    v_mov_b32 v167, 0
    s_and_b32 s4, s2, 7
    s_lshr_b32 s5, s2, 3
    s_and_b32 s6, s4, 1
    s_lshl_b32 s6, s6, 2
    s_and_b32 s7, s5, 3
    s_add_u32 s13, s6, s7
    s_lshr_b32 s6, s4, 1
    s_mul_i32 s6, s6, 8
    s_lshr_b32 s7, s5, 2
    s_add_u32 s14, s6, s7
    s_and_b32 s20, s12, 3
    s_lshr_b32 s21, s12, 2
    s_mul_i32 s4, s14, 21846
    s_lshr_b32 s4, s4, 16
    s_mul_i32 s4, s4, 3
    s_sub_u32 s19, s14, s4
    s_lshl_b32 s4, s19, 2
    s_add_u32 s28, s12, s4
    s_cmp_ge_u32 s28, 12
    s_cselect_b32 s4, 12, 0
    s_sub_u32 s28, s28, s4
    s_mov_b32 s86, 0
    s_mov_b32 s87, 0
    s_mov_b32 s89, 0
    s_mov_b32 s91, 32
    s_mov_b32 s92, 8
    s_lshl_b32 s4, s14, 7
    s_add_u32 s88, s4, 27598848
    s_lshl_b32 s4, s13, 7
    s_add_u32 s90, s4, 27602944
    s_mov_b32 s96, 27500544
    s_mov_b32 s97, 27725824
    s_mov_b32 s48, s19
    s_add_u32 s49, s48, 1
    s_cmp_eq_u32 s49, 3
    s_cselect_b32 s49, 0, s49
    s_add_u32 s50, s49, 1
    s_cmp_eq_u32 s50, 3
    s_cselect_b32 s50, 0, s50
    s_lshl_b32 s4, s14, 2
    s_add_u32 s4, s4, s20
    s_mul_i32 s98, s4, 18432
    s_lshl_b32 s5, s20, 11
    s_add_u32 s99, s5, 3072
    v_lshrrev_b32 v4, 3, v0
    v_and_b32 v5, 7, v0
    v_xor_b32 v5, v5, v4
    v_mul_u32_u24 v4, 1152, v4
    v_lshl_add_u32 v4, v5, 4, v4
    s_mov_b32 s35, 0
    s_sub_u32 s4, s2, 210
    s_cmp_lt_u32 s4, 6
    s_cselect_b32 s4, 0, s2
    s_cmp_lt_u32 s4, 48
    s_cselect_b32 s46, 1, 0
    s_cbranch_scc1 st_nx
st_lx:
    s_cmp_lt_u32 s12, 6
    s_cbranch_scc1 st_nx
    s_sub_u32 s4, s12, 6
    s_lshr_b32 s4, s4, 1
    s_and_b32 s5, s12, 1
    s_mul_i32 s22, s4, 384
    s_mul_i32 s6, s14, 73728
    s_add_u32 s22, s22, s6
    s_mul_i32 s6, s5, 36864
    s_add_u32 s22, s22, s6
    s_mul_i32 s24, s4, 24576
    s_lshl_b32 s6, s5, 12
    s_add_u32 s24, s24, s6
    s_add_u32 s24, s24, 3072
    s_add_u32 m0, s24, 0
    s_add_u32 s23, s22, 0
    buffer_load_dwordx4 v4, s[36:39], s23 offen lds
    s_add_u32 m0, s24, 1024
    s_add_u32 s23, s22, 9216
    buffer_load_dwordx4 v4, s[36:39], s23 offen lds
    s_add_u32 m0, s24, 2048
    s_add_u32 s23, s22, 18432
    buffer_load_dwordx4 v4, s[36:39], s23 offen lds
    s_add_u32 m0, s24, 3072
    s_add_u32 s23, s22, 27648
    buffer_load_dwordx4 v4, s[36:39], s23 offen lds
    s_add_u32 m0, s24, 8192
    s_add_u32 s23, s22, 128
    buffer_load_dwordx4 v4, s[36:39], s23 offen lds
    s_add_u32 m0, s24, 9216
    s_add_u32 s23, s22, 9344
    buffer_load_dwordx4 v4, s[36:39], s23 offen lds
    s_add_u32 m0, s24, 10240
    s_add_u32 s23, s22, 18560
    buffer_load_dwordx4 v4, s[36:39], s23 offen lds
    s_add_u32 m0, s24, 11264
    s_add_u32 s23, s22, 27776
    buffer_load_dwordx4 v4, s[36:39], s23 offen lds
    s_add_u32 m0, s24, 16384
    s_add_u32 s23, s22, 256
    buffer_load_dwordx4 v4, s[36:39], s23 offen lds
    s_add_u32 m0, s24, 17408
    s_add_u32 s23, s22, 9472
    buffer_load_dwordx4 v4, s[36:39], s23 offen lds
    s_add_u32 m0, s24, 18432
    s_add_u32 s23, s22, 18688
    buffer_load_dwordx4 v4, s[36:39], s23 offen lds
    s_add_u32 m0, s24, 19456
    s_add_u32 s23, s22, 27904
    buffer_load_dwordx4 v4, s[36:39], s23 offen lds
st_nx:
    s_cmp_eq_u32 s46, 2
    s_cbranch_scc1 st_x2
    s_cmp_eq_u32 s47, 1
    s_cbranch_scc1 st_j
    s_waitcnt vmcnt(0)
st_j:
    s_cmp_eq_u32 s12, 11
    s_cselect_b32 s4, s2, 255
    s_cmp_lt_u32 s4, 48
    s_cbranch_scc0 st_z_ok
    s_mov_b32 s5, 0
st_z:
    s_mov_b32 s4, 0
    s_atomic_add s4, s[52:53], 128 glc
    s_add_u32 s5, s5, 1
    s_cmp_lt_u32 s5, 0x40000
    s_cbranch_scc0 mega_end
    s_waitcnt lgkmcnt(0)
    s_cmp_ge_u32 s4, 6
    s_cbranch_scc0 st_z
st_z_ok:
    s_barrier
    s_cmp_eq_u32 s46, 0
    s_cbranch_scc1 st_x2
    s_cmp_eq_u32 s12, 11
    s_cbranch_scc0 st_a1
    s_mov_b32 s7, 1
    s_cmp_lt_u32 s2, 48
    s_cbranch_scc1 st_a1_q
    s_atomic_add s7, s[52:53], 128
    s_branch st_a1
st_a1_q:
    v_mov_b32 v7, 1
    s_and_b32 s6, s2, 7
    s_lshl_b32 s6, s6, 2
    s_add_u32 s6, s6, 27721728
    v_lshlrev_b32 v6, 7, v0
    s_mov_b32 exec_hi, 0
    buffer_atomic_add v7, v6, s[8:11], s6 offen sc1
    s_mov_b32 exec_hi, -1
    s_atomic_add s7, s[52:53], 0
st_a1:
    s_barrier
    s_mov_b32 s46, 2
    s_branch st_lx
st_x2:
    s_cmp_lt_u32 s12, 8
    s_cbranch_scc1 st_n2
    s_cmp_lt_u32 s2, 94
    s_cbranch_scc1 st_n2
    s_sub_u32 s4, s2, 94
    s_lshl_b32 s4, s4, 2
    s_add_u32 s4, s4, s20
    s_mul_i32 s33, s4, 7282
    s_lshr_b32 s33, s33, 16
    s_mul_i32 s5, s33, 9
    s_sub_u32 s34, s4, s5
    s_lshl_b32 s34, s34, 1
    s_mul_i32 s35, s33, 7282
    s_lshr_b32 s35, s35, 16
    s_mul_i32 s5, s35, 9
    s_sub_u32 s5, s33, s5
    s_mul_i32 s4, s35, 18
    s_add_u32 s4, s4, s34
    s_mul_i32 s23, s4, 36864
    s_lshl_b32 s5, s5, 7
    s_add_u32 s23, s23, s5
    s_lshl_b32 s35, s35, 7
    s_add_u32 s35, s35, 27603968
    s_lshl_b32 s22, s20, 13
    s_add_u32 s22, s22, 76800
    s_mov_b32 s40, s100
    s_mov_b32 s41, s101
    s_mov_b32 s42, 5308416
    s_mov_b32 s43, 0x20000
    v_lshrrev_b32 v8, 3, v0
    v_mul_u32_u24 v8, 1152, v8
    v_and_b32 v5, 7, v0
    v_lshrrev_b32 v6, 2, v0
    v_and_b32 v6, 4, v6
    v_xor_b32 v5, v5, v6
    v_lshl_add_u32 v8, v5, 4, v8
    s_add_u32 m0, s22, 0
    s_add_u32 s4, s23, 0
    buffer_load_dwordx4 v8, s[40:43], s4 offen nt lds
    s_add_u32 m0, s22, 1024
    s_add_u32 s4, s23, 9216
    buffer_load_dwordx4 v8, s[40:43], s4 offen nt lds
    s_add_u32 m0, s22, 2048
    s_add_u32 s4, s23, 18432
    buffer_load_dwordx4 v8, s[40:43], s4 offen nt lds
    s_add_u32 m0, s22, 3072
    s_add_u32 s4, s23, 27648
    buffer_load_dwordx4 v8, s[40:43], s4 offen nt lds
    s_add_u32 m0, s22, 4096
    s_add_u32 s4, s23, 36864
    buffer_load_dwordx4 v8, s[40:43], s4 offen nt lds
    s_add_u32 m0, s22, 5120
    s_add_u32 s4, s23, 46080
    buffer_load_dwordx4 v8, s[40:43], s4 offen nt lds
    s_add_u32 m0, s22, 6144
    s_add_u32 s4, s23, 55296
    buffer_load_dwordx4 v8, s[40:43], s4 offen nt lds
    s_add_u32 m0, s22, 7168
    s_add_u32 s4, s23, 64512
    buffer_load_dwordx4 v8, s[40:43], s4 offen nt lds
st_n2:
    s_cmp_eq_u32 s12, 7
    s_cbranch_scc0 st_w
    s_lshl_b32 s51, s14, 7
    s_lshl_b32 s4, s13, 2
    s_add_u32 s51, s51, s4
    s_add_u32 s51, s51, 27721728
    v_lshlrev_b32 v4, 2, v0
    v_mov_b32 v5, 0x040404
    s_mov_b64 exec, 0xff
    ds_write_b32 v4, v167 offset:512
    ds_write_b32 v167, v5 offset:520
    s_mov_b64 exec, -1
    s_mov_b32 s5, 0
st_b:
    s_mov_b32 s4, 0
    s_atomic_add s4, s[8:9], s51 glc
    s_waitcnt lgkmcnt(0)
    s_cmp_eq_u32 s4, 6
    s_cbranch_scc1 st_b_ok
    s_add_u32 s5, s5, 1
    s_and_b32 s4, s5, 15
    s_cbranch_scc1 st_b
    s_atomic_add s4, s[52:53], 0 glc
    s_waitcnt lgkmcnt(0)
    s_cmp_ge_u32 s4, 48
    s_cbranch_scc1 st_b_ok
    s_cmp_lt_u32 s5, 0x40000
    s_cbranch_scc1 st_b
    s_endpgm
st_b_ok:
st_w:
    s_waitcnt vmcnt(8)
    s_cmp_eq_u32 s35, 0
    s_cbranch_scc0 st_w2
    s_waitcnt vmcnt(0)
st_w2:
    s_barrier
    s_mov_b32 s89, 8
    s_cmp_lt_u32 s12, 8
    s_cbranch_scc1 st_lo
    s_cmp_eq_u32 s12, 11
    s_cbranch_scc0 st_h
    s_mov_b32 s5, 0
    s_mov_b32 s4, 1
    s_atomic_add s4, s[8:9], s88 glc
    s_waitcnt lgkmcnt(0)
    s_add_u32 s4, s4, 1
    s_cmp_ge_u32 s4, s89
    s_cbranch_scc1 st_c_ok
st_c:
    s_mov_b32 s4, 0
    s_atomic_add s4, s[8:9], s88 glc
    s_waitcnt lgkmcnt(0)
    s_cmp_ge_u32 s4, s89
    s_cbranch_scc1 st_c_ok
    s_sleep 2
    s_add_u32 s5, s5, 1
    s_cmp_lt_u32 s5, 0x40000
    s_cbranch_scc1 st_c
    s_endpgm
st_c_ok:
    s_add_u32 s6, s90, 2048
    s_mov_b32 s7, 32
    s_mov_b32 s5, 0
    s_mov_b32 s4, 1
    s_atomic_add s4, s[8:9], s6 glc
    s_waitcnt lgkmcnt(0)
    s_add_u32 s4, s4, 1
    s_cmp_ge_u32 s4, s7
    s_cbranch_scc1 st_e_ok
st_e:
    s_mov_b32 s4, 0
    s_atomic_add s4, s[8:9], s6 glc
    s_waitcnt lgkmcnt(0)
    s_cmp_ge_u32 s4, s7
    s_cbranch_scc1 st_e_ok
    s_sleep 4
    s_add_u32 s5, s5, 1
    s_cmp_lt_u32 s5, 0x40000
    s_cbranch_scc1 st_e
    s_endpgm
st_e_ok:
    v_mov_b32 v5, 1
    ds_write_b32 v167, v5 offset:528
    s_branch s1_wo0
st_h:
    s_mov_b32 s5, 0
st_d:
    ds_read_b32 v5, v167 offset:528
    s_waitcnt lgkmcnt(0)
    v_readfirstlane_b32 s4, v5
    s_nop 0
    s_and_b32 s4, s4, 0x1
    s_cmp_eq_u32 s4, 0x1
    s_cbranch_scc1 st_d_ok
    s_sleep 1
    s_add_u32 s5, s5, 1
    s_cmp_lt_u32 s5, 0x40000
    s_cbranch_scc1 st_d
    s_endpgm
st_d_ok:
    s_branch s1_wo0
st_lo:
    s_cmp_eq_u32 s12, 7
    s_cbranch_scc1 s1_go
    s_cmp_eq_u32 s12, 6
    s_cbranch_scc0 st_f
    s_setprio 2
st_f:
    s_lshr_b32 s4, 0x43, s12
    s_and_b32 s4, s4, 1
    s_cbranch_scc1 st_g
    s_mov_b32 s33, 0x3000000
    s_mov_b32 s5, 0
st_r2:
    ds_read_b32 v6, v167 offset:520
    s_waitcnt lgkmcnt(0)
    v_readfirstlane_b32 s4, v6
    s_nop 0
    s_cmp_ge_u32 s4, s33
    s_cbranch_scc1 st_r2_ok
    s_sleep 1
    s_add_u32 s5, s5, 1
    s_cmp_lt_u32 s5, 0x40000
    s_cbranch_scc1 st_r2
    s_endpgm
st_r2_ok:
st_g:
    s_mov_b32 s26, 0
    s_branch s1_f1
    s_cmp_ge_u32 s12, 8
    s_cbranch_scc0 s1_lo
    s_barrier
    v_mov_b32 v5, 0x100
    s_waitcnt vmcnt(6)
    s_mov_b64 exec, 1
    ds_add_u32 v167, v5 offset:520
    s_mov_b64 exec, -1
    v_mov_b32 v5, 0x10000
    s_waitcnt vmcnt(0)
    s_mov_b64 exec, 1
    ds_add_u32 v167, v5 offset:520
    s_mov_b64 exec, -1
    s_branch s1_wo
s1_lo:
    s_lshr_b32 s26, 0x43, s12
    s_and_b32 s26, s26, 1
    s_cbranch_scc1 s1_f1
    s_waitcnt vmcnt(0)
    s_barrier
    s_cmp_ge_u32 s12, 7
    s_cbranch_scc1 s1_go
s1_f1:
    s_mul_i32 s15, s13, 7
    s_add_u32 s15, s15, s12
    s_mul_i32 s15, s15, 36864
    s_add_u32 s15, s15, 0
    s_mul_i32 s4, s48, 12288
    s_add_u32 s30, s4, s15
    s_mul_i32 s4, s49, 12288
    s_add_u32 s31, s4, s15
    s_mul_i32 s4, s50, 12288
    s_add_u32 s32, s4, s15
    s_add_u32 s15, s30, 0
    buffer_load_dwordx4 v[40:43], v1, s[8:11], s15 offen offset:0 sc1
    buffer_load_dwordx4 v[44:47], v1, s[8:11], s15 offen offset:1024 sc1
    buffer_load_dwordx4 v[48:51], v1, s[8:11], s15 offen offset:2048 sc1
    buffer_load_dwordx4 v[52:55], v1, s[8:11], s15 offen offset:3072 sc1
    s_add_u32 s15, s30, 4096
    buffer_load_dwordx4 v[56:59], v1, s[8:11], s15 offen offset:0 sc1
    buffer_load_dwordx4 v[60:63], v1, s[8:11], s15 offen offset:1024 sc1
    buffer_load_dwordx4 v[64:67], v1, s[8:11], s15 offen offset:2048 sc1
    buffer_load_dwordx4 v[68:71], v1, s[8:11], s15 offen offset:3072 sc1
    s_add_u32 s15, s30, 8192
    buffer_load_dwordx4 v[72:75], v1, s[8:11], s15 offen offset:0 sc1
    buffer_load_dwordx4 v[76:79], v1, s[8:11], s15 offen offset:1024 sc1
    buffer_load_dwordx4 v[80:83], v1, s[8:11], s15 offen offset:2048 sc1
    buffer_load_dwordx4 v[84:87], v1, s[8:11], s15 offen offset:3072 sc1
    s_add_u32 s15, s31, 0
    buffer_load_dwordx4 v[88:91], v1, s[8:11], s15 offen offset:0 sc1
    buffer_load_dwordx4 v[92:95], v1, s[8:11], s15 offen offset:1024 sc1
    buffer_load_dwordx4 v[96:99], v1, s[8:11], s15 offen offset:2048 sc1
    buffer_load_dwordx4 v[100:103], v1, s[8:11], s15 offen offset:3072 sc1
    s_add_u32 s15, s31, 4096
    buffer_load_dwordx4 v[104:107], v1, s[8:11], s15 offen offset:0 sc1
    buffer_load_dwordx4 v[108:111], v1, s[8:11], s15 offen offset:1024 sc1
    s_cmp_eq_u32 s26, 0
    s_cbranch_scc1 s1_go
    s_waitcnt vmcnt(18)
    s_barrier
s1_go:
    s_lshl_b32 s4, 0, 10
    v_add_u32 v4, s4, v1
    s_cmp_eq_u32 s86, 0
    s_cbranch_scc0 lp1280
    s_lshl_b32 s4, 0, 2
    v_add_u32 v4, s4, v3
    v_and_b32 v6, 7, v2
    v_xor_b32 v4, v4, v6
    v_lshlrev_b32 v4, 4, v4
    v_lshl_add_u32 v4, v2, 7, v4
lp1280:
    s_mul_i32 s4, s48, 24576
    s_add_u32 s4, s4, 3072
    v_add_u32 v144, s4, v4
    s_mul_i32 s4, s49, 24576
    s_add_u32 s4, s4, 3072
    v_add_u32 v146, s4, v4
    s_mul_i32 s4, s50, 24576
    s_add_u32 s4, s4, 3072
    v_add_u32 v148, s4, v4
    s_lshl_b32 s4, 1, 10
    v_add_u32 v4, s4, v1
    s_cmp_eq_u32 s86, 0
    s_cbranch_scc0 lp1300
    s_lshl_b32 s4, 1, 2
    v_add_u32 v4, s4, v3
    v_and_b32 v6, 7, v2
    v_xor_b32 v4, v4, v6
    v_lshlrev_b32 v4, 4, v4
    v_lshl_add_u32 v4, v2, 7, v4
lp1300:
    s_mul_i32 s4, s48, 24576
    s_add_u32 s4, s4, 3072
    v_add_u32 v145, s4, v4
    s_mul_i32 s4, s49, 24576
    s_add_u32 s4, s4, 3072
    v_add_u32 v147, s4, v4
    s_mul_i32 s4, s50, 24576
    s_add_u32 s4, s4, 3072
    v_add_u32 v149, s4, v4
    v_mov_b32 v7, 0x1000000
    ds_read_b128 v[112:115], v144 offset:0
    ds_read_b128 v[116:119], v144 offset:2048
    ds_read_b128 v[120:123], v144 offset:4096
    ds_read_b128 v[124:127], v144 offset:6144
    s_cmp_lt_u32 s12, 4
    s_cbranch_scc1 s1_nn
    s_cmp_eq_u32 s12, 6
    s_cbranch_scc1 s1_nt
    s_cmp_eq_u32 s12, 7
    s_cbranch_scc1 s1_stats
    s_waitcnt vmcnt(17) lgkmcnt(0)
    v_mfma_f32_16x16x32_bf16 v[8:11], v[40:43], v[112:115], 0
    ds_read_b128 v[128:131], v145 offset:0
    ds_read_b128 v[132:135], v145 offset:2048
    v_mfma_f32_16x16x32_bf16 v[12:15], v[40:43], v[116:119], 0
    ds_read_b128 v[136:139], v145 offset:4096
    ds_read_b128 v[140:143], v145 offset:6144
    v_mfma_f32_16x16x32_bf16 v[16:19], v[40:43], v[120:123], 0
    s_waitcnt vmcnt(16)
    v_mfma_f32_16x16x32_bf16 v[20:23], v[40:43], v[124:127], 0
    buffer_load_dwordx4 v[40:43], v1, s[8:11], s15 offen offset:2048 sc1
    v_mfma_f32_16x16x32_bf16 v[36:39], v[44:47], v[124:127], 0
    v_mfma_f32_16x16x32_bf16 v[32:35], v[44:47], v[120:123], 0
    v_mfma_f32_16x16x32_bf16 v[28:31], v[44:47], v[116:119], 0
    s_waitcnt vmcnt(16) lgkmcnt(0)
    v_mfma_f32_16x16x32_bf16 v[24:27], v[44:47], v[112:115], 0
    buffer_load_dwordx4 v[44:47], v1, s[8:11], s15 offen offset:3072 sc1
    v_mfma_f32_16x16x32_bf16 v[8:11], v[48:51], v[128:131], v[8:11]
    ds_read_b128 v[112:115], v144 offset:8192
    ds_read_b128 v[116:119], v144 offset:10240
    v_mfma_f32_16x16x32_bf16 v[12:15], v[48:51], v[132:135], v[12:15]
    ds_read_b128 v[120:123], v144 offset:12288
    ds_read_b128 v[124:127], v144 offset:14336
    v_mfma_f32_16x16x32_bf16 v[16:19], v[48:51], v[136:139], v[16:19]
    s_waitcnt vmcnt(16)
    v_mfma_f32_16x16x32_bf16 v[20:23], v[48:51], v[140:143], v[20:23]
    s_add_u32 s15, s31, 8192
    buffer_load_dwordx4 v[48:51], v1, s[8:11], s15 offen offset:0 sc1
    v_mfma_f32_16x16x32_bf16 v[36:39], v[52:55], v[140:143], v[36:39]
    v_mfma_f32_16x16x32_bf16 v[32:35], v[52:55], v[136:139], v[32:35]
    v_mfma_f32_16x16x32_bf16 v[28:31], v[52:55], v[132:135], v[28:31]
    s_waitcnt vmcnt(16) lgkmcnt(0)
    v_mfma_f32_16x16x32_bf16 v[24:27], v[52:55], v[128:131], v[24:27]
    buffer_load_dwordx4 v[52:55], v1, s[8:11], s15 offen offset:1024 sc1
    v_mfma_f32_16x16x32_bf16 v[8:11], v[56:59], v[112:115], v[8:11]
    ds_read_b128 v[128:131], v145 offset:8192
    ds_read_b128 v[132:135], v145 offset:10240
    v_mfma_f32_16x16x32_bf16 v[12:15], v[56:59], v[116:119], v[12:15]
    ds_read_b128 v[136:139], v145 offset:12288
    ds_read_b128 v[140:143], v145 offset:14336
    v_mfma_f32_16x16x32_bf16 v[16:19], v[56:59], v[120:123], v[16:19]
    s_waitcnt vmcnt(16)
    v_mfma_f32_16x16x32_bf16 v[20:23], v[56:59], v[124:127], v[20:23]
    buffer_load_dwordx4 v[56:59], v1, s[8:11], s15 offen offset:2048 sc1
    v_mfma_f32_16x16x32_bf16 v[36:39], v[60:63], v[124:127], v[36:39]
    v_mfma_f32_16x16x32_bf16 v[32:35], v[60:63], v[120:123], v[32:35]
    v_mfma_f32_16x16x32_bf16 v[28:31], v[60:63], v[116:119], v[28:31]
    s_waitcnt vmcnt(16) lgkmcnt(0)
    v_mfma_f32_16x16x32_bf16 v[24:27], v[60:63], v[112:115], v[24:27]
    buffer_load_dwordx4 v[60:63], v1, s[8:11], s15 offen offset:3072 sc1
    v_mfma_f32_16x16x32_bf16 v[8:11], v[64:67], v[128:131], v[8:11]
    ds_read_b128 v[112:115], v144 offset:16384
    ds_read_b128 v[116:119], v144 offset:18432
    v_mfma_f32_16x16x32_bf16 v[12:15], v[64:67], v[132:135], v[12:15]
    ds_read_b128 v[120:123], v144 offset:20480
    ds_read_b128 v[124:127], v144 offset:22528
    v_mfma_f32_16x16x32_bf16 v[16:19], v[64:67], v[136:139], v[16:19]
    s_waitcnt vmcnt(16)
    v_mfma_f32_16x16x32_bf16 v[20:23], v[64:67], v[140:143], v[20:23]
    s_add_u32 s15, s32, 0
    buffer_load_dwordx4 v[64:67], v1, s[8:11], s15 offen offset:0 sc1
    v_mfma_f32_16x16x32_bf16 v[36:39], v[68:71], v[140:143], v[36:39]
    v_mfma_f32_16x16x32_bf16 v[32:35], v[68:71], v[136:139], v[32:35]
    v_mfma_f32_16x16x32_bf16 v[28:31], v[68:71], v[132:135], v[28:31]
    s_waitcnt vmcnt(16) lgkmcnt(0)
    v_mfma_f32_16x16x32_bf16 v[24:27], v[68:71], v[128:131], v[24:27]
    buffer_load_dwordx4 v[68:71], v1, s[8:11], s15 offen offset:1024 sc1
    v_mfma_f32_16x16x32_bf16 v[8:11], v[72:75], v[112:115], v[8:11]
    ds_read_b128 v[128:131], v145 offset:16384
    ds_read_b128 v[132:135], v145 offset:18432
    v_mfma_f32_16x16x32_bf16 v[12:15], v[72:75], v[116:119], v[12:15]
    ds_read_b128 v[136:139], v145 offset:20480
    ds_read_b128 v[140:143], v145 offset:22528
    v_mfma_f32_16x16x32_bf16 v[16:19], v[72:75], v[120:123], v[16:19]
    s_waitcnt vmcnt(16)
    ds_read_b32 v6, v167 offset:520
    v_mfma_f32_16x16x32_bf16 v[20:23], v[72:75], v[124:127], v[20:23]
    buffer_load_dwordx4 v[72:75], v1, s[8:11], s15 offen offset:2048 sc1
    v_mfma_f32_16x16x32_bf16 v[36:39], v[76:79], v[124:127], v[36:39]
    v_mfma_f32_16x16x32_bf16 v[32:35], v[76:79], v[120:123], v[32:35]
    v_mfma_f32_16x16x32_bf16 v[28:31], v[76:79], v[116:119], v[28:31]
    s_waitcnt vmcnt(16) lgkmcnt(0)
    v_readfirstlane_b32 s4, v6
    v_mfma_f32_16x16x32_bf16 v[24:27], v[76:79], v[112:115], v[24:27]
    buffer_load_dwordx4 v[76:79], v1, s[8:11], s15 offen offset:3072 sc1
    s_andn2_b32 s4, 0x400, s4
    s_cbranch_scc1 s1_slowTT4
s1_backTT4:
    v_mfma_f32_16x16x32_bf16 v[8:11], v[80:83], v[128:131], v[8:11]
    ds_read_b128 v[112:115], v146 offset:0
    ds_read_b128 v[116:119], v146 offset:2048
    v_mfma_f32_16x16x32_bf16 v[12:15], v[80:83], v[132:135], v[12:15]
    ds_read_b128 v[120:123], v146 offset:4096
    ds_read_b128 v[124:127], v146 offset:6144
    v_mfma_f32_16x16x32_bf16 v[16:19], v[80:83], v[136:139], v[16:19]
    s_waitcnt vmcnt(16)
    v_mfma_f32_16x16x32_bf16 v[20:23], v[80:83], v[140:143], v[20:23]
    s_add_u32 s15, s32, 4096
    buffer_load_dwordx4 v[80:83], v1, s[8:11], s15 offen offset:0 sc1
    v_mfma_f32_16x16x32_bf16 v[36:39], v[84:87], v[140:143], v[36:39]
    v_mfma_f32_16x16x32_bf16 v[32:35], v[84:87], v[136:139], v[32:35]
    v_mfma_f32_16x16x32_bf16 v[28:31], v[84:87], v[132:135], v[28:31]
    s_waitcnt vmcnt(16) lgkmcnt(0)
    v_mfma_f32_16x16x32_bf16 v[24:27], v[84:87], v[128:131], v[24:27]
    buffer_load_dwordx4 v[84:87], v1, s[8:11], s15 offen offset:1024 sc1
    v_mfma_f32_16x16x32_bf16 v[8:11], v[88:91], v[112:115], v[8:11]
    ds_read_b128 v[128:131], v147 offset:0
    ds_read_b128 v[132:135], v147 offset:2048
    v_mfma_f32_16x16x32_bf16 v[12:15], v[88:91], v[116:119], v[12:15]
    ds_read_b128 v[136:139], v147 offset:4096
    ds_read_b128 v[140:143], v147 offset:6144
    v_mfma_f32_16x16x32_bf16 v[16:19], v[88:91], v[120:123], v[16:19]
    s_waitcnt vmcnt(16)
    v_mfma_f32_16x16x32_bf16 v[20:23], v[88:91], v[124:127], v[20:23]
    buffer_load_dwordx4 v[88:91], v1, s[8:11], s15 offen offset:2048 sc1
    v_mfma_f32_16x16x32_bf16 v[36:39], v[92:95], v[124:127], v[36:39]
    v_mfma_f32_16x16x32_bf16 v[32:35], v[92:95], v[120:123], v[32:35]
    v_mfma_f32_16x16x32_bf16 v[28:31], v[92:95], v[116:119], v[28:31]
    s_waitcnt vmcnt(16) lgkmcnt(0)
    v_mfma_f32_16x16x32_bf16 v[24:27], v[92:95], v[112:115], v[24:27]
    buffer_load_dwordx4 v[92:95], v1, s[8:11], s15 offen offset:3072 sc1
    v_mfma_f32_16x16x32_bf16 v[8:11], v[96:99], v[128:131], v[8:11]
    ds_read_b128 v[112:115], v146 offset:8192
    ds_read_b128 v[116:119], v146 offset:10240
    v_mfma_f32_16x16x32_bf16 v[12:15], v[96:99], v[132:135], v[12:15]
    ds_read_b128 v[120:123], v146 offset:12288
    ds_read_b128 v[124:127], v146 offset:14336
    v_mfma_f32_16x16x32_bf16 v[16:19], v[96:99], v[136:139], v[16:19]
    s_waitcnt vmcnt(16)
    v_mfma_f32_16x16x32_bf16 v[20:23], v[96:99], v[140:143], v[20:23]
    s_add_u32 s15, s32, 8192
    buffer_load_dwordx4 v[96:99], v1, s[8:11], s15 offen offset:0 sc1
    v_mfma_f32_16x16x32_bf16 v[36:39], v[100:103], v[140:143], v[36:39]
    v_mfma_f32_16x16x32_bf16 v[32:35], v[100:103], v[136:139], v[32:35]
    v_mfma_f32_16x16x32_bf16 v[28:31], v[100:103], v[132:135], v[28:31]
    s_waitcnt vmcnt(16) lgkmcnt(0)
    v_mfma_f32_16x16x32_bf16 v[24:27], v[100:103], v[128:131], v[24:27]
    buffer_load_dwordx4 v[100:103], v1, s[8:11], s15 offen offset:1024 sc1
    v_mfma_f32_16x16x32_bf16 v[8:11], v[104:107], v[112:115], v[8:11]
    ds_read_b128 v[128:131], v147 offset:8192
    ds_read_b128 v[132:135], v147 offset:10240
    v_mfma_f32_16x16x32_bf16 v[12:15], v[104:107], v[116:119], v[12:15]
    ds_read_b128 v[136:139], v147 offset:12288
    ds_read_b128 v[140:143], v147 offset:14336
    v_mfma_f32_16x16x32_bf16 v[16:19], v[104:107], v[120:123], v[16:19]
    s_waitcnt vmcnt(16)
    v_mfma_f32_16x16x32_bf16 v[20:23], v[104:107], v[124:127], v[20:23]
    buffer_load_dwordx4 v[104:107], v1, s[8:11], s15 offen offset:2048 sc1
    v_mfma_f32_16x16x32_bf16 v[36:39], v[108:111], v[124:127], v[36:39]
    s_mov_b64 exec, 1
    ds_add_u32 v167, v7 offset:520
    s_mov_b64 exec, -1
    v_mfma_f32_16x16x32_bf16 v[32:35], v[108:111], v[120:123], v[32:35]
    v_mfma_f32_16x16x32_bf16 v[28:31], v[108:111], v[116:119], v[28:31]
    s_waitcnt vmcnt(16) lgkmcnt(0)
    v_mfma_f32_16x16x32_bf16 v[24:27], v[108:111], v[112:115], v[24:27]
    buffer_load_dwordx4 v[108:111], v1, s[8:11], s15 offen offset:3072 sc1
    v_mfma_f32_16x16x32_bf16 v[8:11], v[40:43], v[128:131], v[8:11]
    ds_read_b128 v[112:115], v146 offset:16384
    ds_read_b128 v[116:119], v146 offset:18432
    v_mfma_f32_16x16x32_bf16 v[12:15], v[40:43], v[132:135], v[12:15]
    ds_read_b128 v[120:123], v146 offset:20480
    ds_read_b128 v[124:127], v146 offset:22528
    v_mfma_f32_16x16x32_bf16 v[16:19], v[40:43], v[136:139], v[16:19]
    s_waitcnt vmcnt(16)
    v_mfma_f32_16x16x32_bf16 v[20:23], v[40:43], v[140:143], v[20:23]
    v_mfma_f32_16x16x32_bf16 v[36:39], v[44:47], v[140:143], v[36:39]
    v_mfma_f32_16x16x32_bf16 v[32:35], v[44:47], v[136:139], v[32:35]
    v_mfma_f32_16x16x32_bf16 v[28:31], v[44:47], v[132:135], v[28:31]
    s_waitcnt vmcnt(15) lgkmcnt(0)
    v_mfma_f32_16x16x32_bf16 v[24:27], v[44:47], v[128:131], v[24:27]
    v_mfma_f32_16x16x32_bf16 v[8:11], v[48:51], v[112:115], v[8:11]
    ds_read_b128 v[128:131], v147 offset:16384
    ds_read_b128 v[132:135], v147 offset:18432
    v_mfma_f32_16x16x32_bf16 v[12:15], v[48:51], v[116:119], v[12:15]
    ds_read_b128 v[136:139], v147 offset:20480
    ds_read_b128 v[140:143], v147 offset:22528
    v_mfma_f32_16x16x32_bf16 v[16:19], v[48:51], v[120:123], v[16:19]
    s_waitcnt vmcnt(14)
    ds_read_b32 v6, v167 offset:520
    v_mfma_f32_16x16x32_bf16 v[20:23], v[48:51], v[124:127], v[20:23]
    v_mfma_f32_16x16x32_bf16 v[36:39], v[52:55], v[124:127], v[36:39]
    v_mfma_f32_16x16x32_bf16 v[32:35], v[52:55], v[120:123], v[32:35]
    v_mfma_f32_16x16x32_bf16 v[28:31], v[52:55], v[116:119], v[28:31]
    s_waitcnt vmcnt(13) lgkmcnt(0)
    v_readfirstlane_b32 s4, v6
    v_mfma_f32_16x16x32_bf16 v[24:27], v[52:55], v[112:115], v[24:27]
    s_andn2_b32 s4, 0x40000, s4
    s_cbranch_scc1 s1_slowTT10
s1_backTT10:
    v_mfma_f32_16x16x32_bf16 v[8:11], v[56:59], v[128:131], v[8:11]
    ds_read_b128 v[112:115], v148 offset:0
    ds_read_b128 v[116:119], v148 offset:2048
    v_mfma_f32_16x16x32_bf16 v[12:15], v[56:59], v[132:135], v[12:15]
    ds_read_b128 v[120:123], v148 offset:4096
    ds_read_b128 v[124:127], v148 offset:6144
    v_mfma_f32_16x16x32_bf16 v[16:19], v[56:59], v[136:139], v[16:19]
    s_waitcnt vmcnt(12)
    v_mfma_f32_16x16x32_bf16 v[20:23], v[56:59], v[140:143], v[20:23]
    v_mfma_f32_16x16x32_bf16 v[36:39], v[60:63], v[140:143], v[36:39]
    v_mfma_f32_16x16x32_bf16 v[32:35], v[60:63], v[136:139], v[32:35]
    v_mfma_f32_16x16x32_bf16 v[28:31], v[60:63], v[132:135], v[28:31]
    s_waitcnt vmcnt(11) lgkmcnt(0)
    v_mfma_f32_16x16x32_bf16 v[24:27], v[60:63], v[128:131], v[24:27]
    v_mfma_f32_16x16x32_bf16 v[8:11], v[64:67], v[112:115], v[8:11]
    ds_read_b128 v[128:131], v149 offset:0
    ds_read_b128 v[132:135], v149 offset:2048
    v_mfma_f32_16x16x32_bf16 v[12:15], v[64:67], v[116:119], v[12:15]
    ds_read_b128 v[136:139], v149 offset:4096
    ds_read_b128 v[140:143], v149 offset:6144
    v_mfma_f32_16x16x32_bf16 v[16:19], v[64:67], v[120:123], v[16:19]
    s_waitcnt vmcnt(10)
    v_mfma_f32_16x16x32_bf16 v[20:23], v[64:67], v[124:127], v[20:23]
    v_mfma_f32_16x16x32_bf16 v[36:39], v[68:71], v[124:127], v[36:39]
    v_mfma_f32_16x16x32_bf16 v[32:35], v[68:71], v[120:123], v[32:35]
    v_mfma_f32_16x16x32_bf16 v[28:31], v[68:71], v[116:119], v[28:31]
    s_waitcnt vmcnt(9) lgkmcnt(0)
    v_mfma_f32_16x16x32_bf16 v[24:27], v[68:71], v[112:115], v[24:27]
    v_mfma_f32_16x16x32_bf16 v[8:11], v[72:75], v[128:131], v[8:11]
    ds_read_b128 v[112:115], v148 offset:8192
    ds_read_b128 v[116:119], v148 offset:10240
    v_mfma_f32_16x16x32_bf16 v[12:15], v[72:75], v[132:135], v[12:15]
    ds_read_b128 v[120:123], v148 offset:12288
    ds_read_b128 v[124:127], v148 offset:14336
    v_mfma_f32_16x16x32_bf16 v[16:19], v[72:75], v[136:139], v[16:19]
    s_waitcnt vmcnt(8)
    v_mfma_f32_16x16x32_bf16 v[20:23], v[72:75], v[140:143], v[20:23]
    v_mfma_f32_16x16x32_bf16 v[36:39], v[76:79], v[140:143], v[36:39]
    v_mfma_f32_16x16x32_bf16 v[32:35], v[76:79], v[136:139], v[32:35]
    v_mfma_f32_16x16x32_bf16 v[28:31], v[76:79], v[132:135], v[28:31]
    s_waitcnt vmcnt(7) lgkmcnt(0)
    v_mfma_f32_16x16x32_bf16 v[24:27], v[76:79], v[128:131], v[24:27]
    v_mfma_f32_16x16x32_bf16 v[8:11], v[80:83], v[112:115], v[8:11]
    ds_read_b128 v[128:131], v149 offset:8192
    ds_read_b128 v[132:135], v149 offset:10240
    v_mfma_f32_16x16x32_bf16 v[12:15], v[80:83], v[116:119], v[12:15]
    ds_read_b128 v[136:139], v149 offset:12288
    ds_read_b128 v[140:143], v149 offset:14336
    v_mfma_f32_16x16x32_bf16 v[16:19], v[80:83], v[120:123], v[16:19]
    s_waitcnt vmcnt(6)
    v_mfma_f32_16x16x32_bf16 v[20:23], v[80:83], v[124:127], v[20:23]
    v_mfma_f32_16x16x32_bf16 v[36:39], v[84:87], v[124:127], v[36:39]
    v_mfma_f32_16x16x32_bf16 v[32:35], v[84:87], v[120:123], v[32:35]
    v_mfma_f32_16x16x32_bf16 v[28:31], v[84:87], v[116:119], v[28:31]
    s_waitcnt vmcnt(5) lgkmcnt(0)
    v_mfma_f32_16x16x32_bf16 v[24:27], v[84:87], v[112:115], v[24:27]
    v_mfma_f32_16x16x32_bf16 v[8:11], v[88:91], v[128:131], v[8:11]
    ds_read_b128 v[112:115], v148 offset:16384
    ds_read_b128 v[116:119], v148 offset:18432
    v_mfma_f32_16x16x32_bf16 v[12:15], v[88:91], v[132:135], v[12:15]
    ds_read_b128 v[120:123], v148 offset:20480
    ds_read_b128 v[124:127], v148 offset:22528
    v_mfma_f32_16x16x32_bf16 v[16:19], v[88:91], v[136:139], v[16:19]
    s_waitcnt vmcnt(4)
    v_mfma_f32_16x16x32_bf16 v[20:23], v[88:91], v[140:143], v[20:23]
    v_mfma_f32_16x16x32_bf16 v[36:39], v[92:95], v[140:143], v[36:39]
    v_mfma_f32_16x16x32_bf16 v[32:35], v[92:95], v[136:139], v[32:35]
    v_mfma_f32_16x16x32_bf16 v[28:31], v[92:95], v[132:135], v[28:31]
    s_waitcnt vmcnt(3) lgkmcnt(0)
    v_mfma_f32_16x16x32_bf16 v[24:27], v[92:95], v[128:131], v[24:27]
    v_mfma_f32_16x16x32_bf16 v[8:11], v[96:99], v[112:115], v[8:11]
    ds_read_b128 v[128:131], v149 offset:16384
    ds_read_b128 v[132:135], v149 offset:18432
    v_mfma_f32_16x16x32_bf16 v[12:15], v[96:99], v[116:119], v[12:15]
    ds_read_b128 v[136:139], v149 offset:20480
    ds_read_b128 v[140:143], v149 offset:22528
    v_mfma_f32_16x16x32_bf16 v[16:19], v[96:99], v[120:123], v[16:19]
    s_waitcnt vmcnt(2)
    v_mfma_f32_16x16x32_bf16 v[20:23], v[96:99], v[124:127], v[20:23]
    v_mfma_f32_16x16x32_bf16 v[36:39], v[100:103], v[124:127], v[36:39]
    v_mfma_f32_16x16x32_bf16 v[32:35], v[100:103], v[120:123], v[32:35]
    v_mfma_f32_16x16x32_bf16 v[28:31], v[100:103], v[116:119], v[28:31]
    s_waitcnt vmcnt(1) lgkmcnt(0)
    v_mfma_f32_16x16x32_bf16 v[24:27], v[100:103], v[112:115], v[24:27]
    v_mfma_f32_16x16x32_bf16 v[8:11], v[104:107], v[128:131], v[8:11]
    v_mfma_f32_16x16x32_bf16 v[12:15], v[104:107], v[132:135], v[12:15]
    v_mfma_f32_16x16x32_bf16 v[16:19], v[104:107], v[136:139], v[16:19]
    s_waitcnt vmcnt(0)
    v_mfma_f32_16x16x32_bf16 v[20:23], v[104:107], v[140:143], v[20:23]
    v_mfma_f32_16x16x32_bf16 v[36:39], v[108:111], v[140:143], v[36:39]
    v_mfma_f32_16x16x32_bf16 v[32:35], v[108:111], v[136:139], v[32:35]
    v_mfma_f32_16x16x32_bf16 v[28:31], v[108:111], v[132:135], v[28:31]
    v_mfma_f32_16x16x32_bf16 v[24:27], v[108:111], v[128:131], v[24:27]
    s_mov_b32 s5, 0
s1_sTT:
    ds_read_b32 v6, v167 offset:512
    s_waitcnt lgkmcnt(0)
    v_readfirstlane_b32 s4, v6
    s_nop 0
    s_and_b32 s4, s4, 0x2
    s_cmp_eq_u32 s4, 0x2
    s_cbranch_scc1 s1_sTT_ok
    s_sleep 1
    s_add_u32 s5, s5, 1
    s_cmp_lt_u32 s5, 0x40000
    s_cbranch_scc1 s1_sTT
    s_endpgm
s1_sTT_ok:
    v_lshlrev_b32 v6, 2, v2
    ds_read_b32 v40, v6 offset:0
    ds_read_b32 v41, v6 offset:64
    ds_read_b32 v42, v6 offset:128
    ds_read_b32 v43, v6 offset:192
    ds_read_b32 v44, v6 offset:256
    ds_read_b32 v45, v6 offset:320
    ds_read_b32 v46, v6 offset:384
    ds_read_b32 v47, v6 offset:448
    s_lshl_b32 s6, s14, 4
    s_add_u32 s6, s6, s13
    s_mul_i32 s6, s6, 4608
    s_add_u32 s6, s6, s87
    s_add_u32 s6, s6, 22781952
    s_lshl_b32 s5, s20, 10
    s_add_u32 s6, s6, s5
    s_add_u32 s7, s6, 36864
    s_waitcnt lgkmcnt(0)
    v_mul_f32 v72, v8, v44
    v_mul_f32 v73, v9, v44
    v_mul_f32 v74, v10, v44
    v_mul_f32 v75, v11, v44
    v_mul_f32 v76, v24, v44
    v_mul_f32 v77, v25, v44
    v_mul_f32 v78, v26, v44
    v_mul_f32 v79, v27, v44
    v_min_f32 v72, 0, v72
    v_min_f32 v73, 0, v73
    v_min_f32 v74, 0, v74
    v_min_f32 v75, 0, v75
    v_min_f32 v76, 0, v76
    v_min_f32 v77, 0, v77
    v_min_f32 v78, 0, v78
    v_min_f32 v79, 0, v79
    v_exp_f32 v72, v72
    v_exp_f32 v73, v73
    v_exp_f32 v74, v74
    v_exp_f32 v75, v75
    v_exp_f32 v76, v76
    v_exp_f32 v77, v77
    v_exp_f32 v78, v78
    v_exp_f32 v79, v79
    v_max_f32 v8, 0, v8
    v_max_f32 v9, 0, v9
    v_max_f32 v10, 0, v10
    v_max_f32 v11, 0, v11
    v_max_f32 v24, 0, v24
    v_max_f32 v25, 0, v25
    v_max_f32 v26, 0, v26
    v_max_f32 v27, 0, v27
    v_add_f32 v72, 0x358637bd, v72
    v_add_f32 v73, 0x358637bd, v73
    v_add_f32 v74, 0x358637bd, v74
    v_add_f32 v75, 0x358637bd, v75
    v_add_f32 v76, 0x358637bd, v76
    v_add_f32 v77, 0x358637bd, v77
    v_add_f32 v78, 0x358637bd, v78
    v_add_f32 v79, 0x358637bd, v79
    v_fma_f32 v8, v8, v40, v72
    v_fma_f32 v9, v9, v40, v73
    v_fma_f32 v10, v10, v40, v74
    v_fma_f32 v11, v11, v40, v75
    v_fma_f32 v24, v24, v40, v76
    v_fma_f32 v25, v25, v40, v77
    v_fma_f32 v26, v26, v40, v78
    v_fma_f32 v27, v27, v40, v79
    v_cvt_pk_bf16_f32 v112, v8, v9
    v_cvt_pk_bf16_f32 v113, v10, v11
    v_cvt_pk_bf16_f32 v114, v24, v25
    v_cvt_pk_bf16_f32 v115, v26, v27
    buffer_store_dwordx4 v[112:115], v1, s[8:11], s6 offen offset:0 sc1
    v_mul_f32 v72, v12, v45
    v_mul_f32 v73, v13, v45
    v_mul_f32 v74, v14, v45
    v_mul_f32 v75, v15, v45
    v_mul_f32 v76, v28, v45
    v_mul_f32 v77, v29, v45
    v_mul_f32 v78, v30, v45
    v_mul_f32 v79, v31, v45
    v_min_f32 v72, 0, v72
    v_min_f32 v73, 0, v73
    v_min_f32 v74, 0, v74
    v_min_f32 v75, 0, v75
    v_min_f32 v76, 0, v76
    v_min_f32 v77, 0, v77
    v_min_f32 v78, 0, v78
    v_min_f32 v79, 0, v79
    v_exp_f32 v72, v72
    v_exp_f32 v73, v73
    v_exp_f32 v74, v74
    v_exp_f32 v75, v75
    v_exp_f32 v76, v76
    v_exp_f32 v77, v77
    v_exp_f32 v78, v78
    v_exp_f32 v79, v79
    v_max_f32 v12, 0, v12
    v_max_f32 v13, 0, v13
    v_max_f32 v14, 0, v14
    v_max_f32 v15, 0, v15
    v_max_f32 v28, 0, v28
    v_max_f32 v29, 0, v29
    v_max_f32 v30, 0, v30
    v_max_f32 v31, 0, v31
    v_add_f32 v72, 0x358637bd, v72
    v_add_f32 v73, 0x358637bd, v73
    v_add_f32 v74, 0x358637bd, v74
    v_add_f32 v75, 0x358637bd, v75
    v_add_f32 v76, 0x358637bd, v76
    v_add_f32 v77, 0x358637bd, v77
    v_add_f32 v78, 0x358637bd, v78
    v_add_f32 v79, 0x358637bd, v79
    v_fma_f32 v12, v12, v41, v72
    v_fma_f32 v13, v13, v41, v73
    v_fma_f32 v14, v14, v41, v74
    v_fma_f32 v15, v15, v41, v75
    v_fma_f32 v28, v28, v41, v76
    v_fma_f32 v29, v29, v41, v77
    v_fma_f32 v30, v30, v41, v78
    v_fma_f32 v31, v31, v41, v79
    v_cvt_pk_bf16_f32 v116, v12, v13
    v_cvt_pk_bf16_f32 v117, v14, v15
    v_cvt_pk_bf16_f32 v118, v28, v29
    v_cvt_pk_bf16_f32 v119, v30, v31
    buffer_store_dwordx4 v[116:119], v1, s[8:11], s6 offen offset:2048 sc1
    v_mul_f32 v72, v16, v46
    v_mul_f32 v73, v17, v46
    v_mul_f32 v74, v18, v46
    v_mul_f32 v75, v19, v46
    v_mul_f32 v76, v32, v46
    v_mul_f32 v77, v33, v46
    v_mul_f32 v78, v34, v46
    v_mul_f32 v79, v35, v46
    v_min_f32 v72, 0, v72
    v_min_f32 v73, 0, v73
    v_min_f32 v74, 0, v74
    v_min_f32 v75, 0, v75
    v_min_f32 v76, 0, v76
    v_min_f32 v77, 0, v77
    v_min_f32 v78, 0, v78
    v_min_f32 v79, 0, v79
    v_exp_f32 v72, v72
    v_exp_f32 v73, v73
    v_exp_f32 v74, v74
    v_exp_f32 v75, v75
    v_exp_f32 v76, v76
    v_exp_f32 v77, v77
    v_exp_f32 v78, v78
    v_exp_f32 v79, v79
    v_max_f32 v16, 0, v16
    v_max_f32 v17, 0, v17
    v_max_f32 v18, 0, v18
    v_max_f32 v19, 0, v19
    v_max_f32 v32, 0, v32
    v_max_f32 v33, 0, v33
    v_max_f32 v34, 0, v34
    v_max_f32 v35, 0, v35
    v_add_f32 v72, 0x358637bd, v72
    v_add_f32 v73, 0x358637bd, v73
    v_add_f32 v74, 0x358637bd, v74
    v_add_f32 v75, 0x358637bd, v75
    v_add_f32 v76, 0x358637bd, v76
    v_add_f32 v77, 0x358637bd, v77
    v_add_f32 v78, 0x358637bd, v78
    v_add_f32 v79, 0x358637bd, v79
    v_fma_f32 v16, v16, v42, v72
    v_fma_f32 v17, v17, v42, v73
    v_fma_f32 v18, v18, v42, v74
    v_fma_f32 v19, v19, v42, v75
    v_fma_f32 v32, v32, v42, v76
    v_fma_f32 v33, v33, v42, v77
    v_fma_f32 v34, v34, v42, v78
    v_fma_f32 v35, v35, v42, v79
    v_cvt_pk_bf16_f32 v120, v16, v17
    v_cvt_pk_bf16_f32 v121, v18, v19
    v_cvt_pk_bf16_f32 v122, v32, v33
    v_cvt_pk_bf16_f32 v123, v34, v35
    buffer_store_dwordx4 v[120:123], v1, s[8:11], s7 offen offset:0 sc1
    v_mul_f32 v72, v20, v47
    v_mul_f32 v73, v21, v47
    v_mul_f32 v74, v22, v47
    v_mul_f32 v75, v23, v47
    v_mul_f32 v76, v36, v47
    v_mul_f32 v77, v37, v47
    v_mul_f32 v78, v38, v47
    v_mul_f32 v79, v39, v47
    v_min_f32 v72, 0, v72
    v_min_f32 v73, 0, v73
    v_min_f32 v74, 0, v74
    v_min_f32 v75, 0, v75
    v_min_f32 v76, 0, v76
    v_min_f32 v77, 0, v77
    v_min_f32 v78, 0, v78
    v_min_f32 v79, 0, v79
    v_exp_f32 v72, v72
    v_exp_f32 v73, v73
    v_exp_f32 v74, v74
    v_exp_f32 v75, v75
    v_exp_f32 v76, v76
    v_exp_f32 v77, v77
    v_exp_f32 v78, v78
    v_exp_f32 v79, v79
    v_max_f32 v20, 0, v20
    v_max_f32 v21, 0, v21
    v_max_f32 v22, 0, v22
    v_max_f32 v23, 0, v23
    v_max_f32 v36, 0, v36
    v_max_f32 v37, 0, v37
    v_max_f32 v38, 0, v38
    v_max_f32 v39, 0, v39
    v_add_f32 v72, 0x358637bd, v72
    v_add_f32 v73, 0x358637bd, v73
    v_add_f32 v74, 0x358637bd, v74
    v_add_f32 v75, 0x358637bd, v75
    v_add_f32 v76, 0x358637bd, v76
    v_add_f32 v77, 0x358637bd, v77
    v_add_f32 v78, 0x358637bd, v78
    v_add_f32 v79, 0x358637bd, v79
    v_fma_f32 v20, v20, v43, v72
    v_fma_f32 v21, v21, v43, v73
    v_fma_f32 v22, v22, v43, v74
    v_fma_f32 v23, v23, v43, v75
    v_fma_f32 v36, v36, v43, v76
    v_fma_f32 v37, v37, v43, v77
    v_fma_f32 v38, v38, v43, v78
    v_fma_f32 v39, v39, v43, v79
    v_cvt_pk_bf16_f32 v124, v20, v21
    v_cvt_pk_bf16_f32 v125, v22, v23
    v_cvt_pk_bf16_f32 v126, v36, v37
    v_cvt_pk_bf16_f32 v127, v38, v39
    buffer_store_dwordx4 v[124:127], v1, s[8:11], s7 offen offset:2048 sc1
    s_branch s1_done
s1_nn:
    s_waitcnt vmcnt(17) lgkmcnt(0)
    v_mfma_f32_16x16x32_bf16 v[8:11], v[112:115], v[40:43], 0
    ds_read_b128 v[128:131], v145 offset:0
    ds_read_b128 v[132:135], v145 offset:2048
    v_mfma_f32_16x16x32_bf16 v[12:15], v[116:119], v[40:43], 0
    ds_read_b128 v[136:139], v145 offset:4096
    ds_read_b128 v[140:143], v145 offset:6144
    v_mfma_f32_16x16x32_bf16 v[16:19], v[120:123], v[40:43], 0
    s_waitcnt vmcnt(16)
    v_mfma_f32_16x16x32_bf16 v[20:23], v[124:127], v[40:43], 0
    buffer_load_dwordx4 v[40:43], v1, s[8:11], s15 offen offset:2048 sc1
    v_mfma_f32_16x16x32_bf16 v[36:39], v[124:127], v[44:47], 0
    v_mfma_f32_16x16x32_bf16 v[32:35], v[120:123], v[44:47], 0
    v_mfma_f32_16x16x32_bf16 v[28:31], v[116:119], v[44:47], 0
    s_waitcnt vmcnt(16) lgkmcnt(0)
    v_mfma_f32_16x16x32_bf16 v[24:27], v[112:115], v[44:47], 0
    buffer_load_dwordx4 v[44:47], v1, s[8:11], s15 offen offset:3072 sc1
    v_mfma_f32_16x16x32_bf16 v[8:11], v[128:131], v[48:51], v[8:11]
    ds_read_b128 v[112:115], v144 offset:8192
    ds_read_b128 v[116:119], v144 offset:10240
    v_mfma_f32_16x16x32_bf16 v[12:15], v[132:135], v[48:51], v[12:15]
    ds_read_b128 v[120:123], v144 offset:12288
    ds_read_b128 v[124:127], v144 offset:14336
    v_mfma_f32_16x16x32_bf16 v[16:19], v[136:139], v[48:51], v[16:19]
    s_waitcnt vmcnt(16)
    v_mfma_f32_16x16x32_bf16 v[20:23], v[140:143], v[48:51], v[20:23]
    s_add_u32 s15, s31, 8192
    buffer_load_dwordx4 v[48:51], v1, s[8:11], s15 offen offset:0 sc1
    v_mfma_f32_16x16x32_bf16 v[36:39], v[140:143], v[52:55], v[36:39]
    v_mfma_f32_16x16x32_bf16 v[32:35], v[136:139], v[52:55], v[32:35]
    v_mfma_f32_16x16x32_bf16 v[28:31], v[132:135], v[52:55], v[28:31]
    s_waitcnt vmcnt(16) lgkmcnt(0)
    v_mfma_f32_16x16x32_bf16 v[24:27], v[128:131], v[52:55], v[24:27]
    buffer_load_dwordx4 v[52:55], v1, s[8:11], s15 offen offset:1024 sc1
    v_mfma_f32_16x16x32_bf16 v[8:11], v[112:115], v[56:59], v[8:11]
    ds_read_b128 v[128:131], v145 offset:8192
    ds_read_b128 v[132:135], v145 offset:10240
    v_mfma_f32_16x16x32_bf16 v[12:15], v[116:119], v[56:59], v[12:15]
    ds_read_b128 v[136:139], v145 offset:12288
    ds_read_b128 v[140:143], v145 offset:14336
    v_mfma_f32_16x16x32_bf16 v[16:19], v[120:123], v[56:59], v[16:19]
    s_waitcnt vmcnt(16)
    v_mfma_f32_16x16x32_bf16 v[20:23], v[124:127], v[56:59], v[20:23]
    buffer_load_dwordx4 v[56:59], v1, s[8:11], s15 offen offset:2048 sc1
    v_mfma_f32_16x16x32_bf16 v[36:39], v[124:127], v[60:63], v[36:39]
    v_mfma_f32_16x16x32_bf16 v[32:35], v[120:123], v[60:63], v[32:35]
    v_mfma_f32_16x16x32_bf16 v[28:31], v[116:119], v[60:63], v[28:31]
    s_waitcnt vmcnt(16) lgkmcnt(0)
    v_mfma_f32_16x16x32_bf16 v[24:27], v[112:115], v[60:63], v[24:27]
    buffer_load_dwordx4 v[60:63], v1, s[8:11], s15 offen offset:3072 sc1
    v_mfma_f32_16x16x32_bf16 v[8:11], v[128:131], v[64:67], v[8:11]
    ds_read_b128 v[112:115], v144 offset:16384
    ds_read_b128 v[116:119], v144 offset:18432
    v_mfma_f32_16x16x32_bf16 v[12:15], v[132:135], v[64:67], v[12:15]
    ds_read_b128 v[120:123], v144 offset:20480
    ds_read_b128 v[124:127], v144 offset:22528
    v_mfma_f32_16x16x32_bf16 v[16:19], v[136:139], v[64:67], v[16:19]
    s_waitcnt vmcnt(16)
    v_mfma_f32_16x16x32_bf16 v[20:23], v[140:143], v[64:67], v[20:23]
    s_add_u32 s15, s32, 0
    buffer_load_dwordx4 v[64:67], v1, s[8:11], s15 offen offset:0 sc1
    v_mfma_f32_16x16x32_bf16 v[36:39], v[140:143], v[68:71], v[36:39]
    v_mfma_f32_16x16x32_bf16 v[32:35], v[136:139], v[68:71], v[32:35]
    v_mfma_f32_16x16x32_bf16 v[28:31], v[132:135], v[68:71], v[28:31]
    s_waitcnt vmcnt(16) lgkmcnt(0)
    v_mfma_f32_16x16x32_bf16 v[24:27], v[128:131], v[68:71], v[24:27]
    buffer_load_dwordx4 v[68:71], v1, s[8:11], s15 offen offset:1024 sc1
    v_mfma_f32_16x16x32_bf16 v[8:11], v[112:115], v[72:75], v[8:11]
    ds_read_b128 v[128:131], v145 offset:16384
    ds_read_b128 v[132:135], v145 offset:18432
    v_mfma_f32_16x16x32_bf16 v[12:15], v[116:119], v[72:75], v[12:15]
    ds_read_b128 v[136:139], v145 offset:20480
    ds_read_b128 v[140:143], v145 offset:22528
    v_mfma_f32_16x16x32_bf16 v[16:19], v[120:123], v[72:75], v[16:19]
    s_waitcnt vmcnt(16)
    ds_read_b32 v6, v167 offset:520
    v_mfma_f32_16x16x32_bf16 v[20:23], v[124:127], v[72:75], v[20:23]
    buffer_load_dwordx4 v[72:75], v1, s[8:11], s15 offen offset:2048 sc1
    v_mfma_f32_16x16x32_bf16 v[36:39], v[124:127], v[76:79], v[36:39]
    v_mfma_f32_16x16x32_bf16 v[32:35], v[120:123], v[76:79], v[32:35]
    v_mfma_f32_16x16x32_bf16 v[28:31], v[116:119], v[76:79], v[28:31]
    s_waitcnt vmcnt(16) lgkmcnt(0)
    v_readfirstlane_b32 s4, v6
    v_mfma_f32_16x16x32_bf16 v[24:27], v[112:115], v[76:79], v[24:27]
    buffer_load_dwordx4 v[76:79], v1, s[8:11], s15 offen offset:3072 sc1
    s_andn2_b32 s4, 0x400, s4
    s_cbranch_scc1 s1_slowNN4
s1_backNN4:
    v_mfma_f32_16x16x32_bf16 v[8:11], v[128:131], v[80:83], v[8:11]
    ds_read_b128 v[112:115], v146 offset:0
    ds_read_b128 v[116:119], v146 offset:2048
    v_mfma_f32_16x16x32_bf16 v[12:15], v[132:135], v[80:83], v[12:15]
    ds_read_b128 v[120:123], v146 offset:4096
    ds_read_b128 v[124:127], v146 offset:6144
    v_mfma_f32_16x16x32_bf16 v[16:19], v[136:139], v[80:83], v[16:19]
    s_waitcnt vmcnt(16)
    v_mfma_f32_16x16x32_bf16 v[20:23], v[140:143], v[80:83], v[20:23]
    s_add_u32 s15, s32, 4096
    buffer_load_dwordx4 v[80:83], v1, s[8:11], s15 offen offset:0 sc1
    v_mfma_f32_16x16x32_bf16 v[36:39], v[140:143], v[84:87], v[36:39]
    v_mfma_f32_16x16x32_bf16 v[32:35], v[136:139], v[84:87], v[32:35]
    v_mfma_f32_16x16x32_bf16 v[28:31], v[132:135], v[84:87], v[28:31]
    s_waitcnt vmcnt(16) lgkmcnt(0)
    v_mfma_f32_16x16x32_bf16 v[24:27], v[128:131], v[84:87], v[24:27]
    buffer_load_dwordx4 v[84:87], v1, s[8:11], s15 offen offset:1024 sc1
    v_mfma_f32_16x16x32_bf16 v[8:11], v[112:115], v[88:91], v[8:11]
    ds_read_b128 v[128:131], v147 offset:0
    ds_read_b128 v[132:135], v147 offset:2048
    v_mfma_f32_16x16x32_bf16 v[12:15], v[116:119], v[88:91], v[12:15]
    ds_read_b128 v[136:139], v147 offset:4096
    ds_read_b128 v[140:143], v147 offset:6144
    v_mfma_f32_16x16x32_bf16 v[16:19], v[120:123], v[88:91], v[16:19]
    s_waitcnt vmcnt(16)
    v_mfma_f32_16x16x32_bf16 v[20:23], v[124:127], v[88:91], v[20:23]
    buffer_load_dwordx4 v[88:91], v1, s[8:11], s15 offen offset:2048 sc1
    v_mfma_f32_16x16x32_bf16 v[36:39], v[124:127], v[92:95], v[36:39]
    v_mfma_f32_16x16x32_bf16 v[32:35], v[120:123], v[92:95], v[32:35]
    v_mfma_f32_16x16x32_bf16 v[28:31], v[116:119], v[92:95], v[28:31]
    s_waitcnt vmcnt(16) lgkmcnt(0)
    v_mfma_f32_16x16x32_bf16 v[24:27], v[112:115], v[92:95], v[24:27]
    buffer_load_dwordx4 v[92:95], v1, s[8:11], s15 offen offset:3072 sc1
    v_mfma_f32_16x16x32_bf16 v[8:11], v[128:131], v[96:99], v[8:11]
    ds_read_b128 v[112:115], v146 offset:8192
    ds_read_b128 v[116:119], v146 offset:10240
    v_mfma_f32_16x16x32_bf16 v[12:15], v[132:135], v[96:99], v[12:15]
    ds_read_b128 v[120:123], v146 offset:12288
    ds_read_b128 v[124:127], v146 offset:14336
    v_mfma_f32_16x16x32_bf16 v[16:19], v[136:139], v[96:99], v[16:19]
    s_waitcnt vmcnt(16)
    v_mfma_f32_16x16x32_bf16 v[20:23], v[140:143], v[96:99], v[20:23]
    s_add_u32 s15, s32, 8192
    buffer_load_dwordx4 v[96:99], v1, s[8:11], s15 offen offset:0 sc1
    v_mfma_f32_16x16x32_bf16 v[36:39], v[140:143], v[100:103], v[36:39]
    v_mfma_f32_16x16x32_bf16 v[32:35], v[136:139], v[100:103], v[32:35]
    v_mfma_f32_16x16x32_bf16 v[28:31], v[132:135], v[100:103], v[28:31]
    s_waitcnt vmcnt(16) lgkmcnt(0)
    v_mfma_f32_16x16x32_bf16 v[24:27], v[128:131], v[100:103], v[24:27]
    buffer_load_dwordx4 v[100:103], v1, s[8:11], s15 offen offset:1024 sc1
    v_mfma_f32_16x16x32_bf16 v[8:11], v[112:115], v[104:107], v[8:11]
    ds_read_b128 v[128:131], v147 offset:8192
    ds_read_b128 v[132:135], v147 offset:10240
    v_mfma_f32_16x16x32_bf16 v[12:15], v[116:119], v[104:107], v[12:15]
    ds_read_b128 v[136:139], v147 offset:12288
    ds_read_b128 v[140:143], v147 offset:14336
    v_mfma_f32_16x16x32_bf16 v[16:19], v[120:123], v[104:107], v[16:19]
    s_waitcnt vmcnt(16)
    v_mfma_f32_16x16x32_bf16 v[20:23], v[124:127], v[104:107], v[20:23]
    buffer_load_dwordx4 v[104:107], v1, s[8:11], s15 offen offset:2048 sc1
    v_mfma_f32_16x16x32_bf16 v[36:39], v[124:127], v[108:111], v[36:39]
    s_mov_b64 exec, 1
    ds_add_u32 v167, v7 offset:520
    s_mov_b64 exec, -1
    v_mfma_f32_16x16x32_bf16 v[32:35], v[120:123], v[108:111], v[32:35]
    v_mfma_f32_16x16x32_bf16 v[28:31], v[116:119], v[108:111], v[28:31]
    s_waitcnt vmcnt(16) lgkmcnt(0)
    v_mfma_f32_16x16x32_bf16 v[24:27], v[112:115], v[108:111], v[24:27]
    buffer_load_dwordx4 v[108:111], v1, s[8:11], s15 offen offset:3072 sc1
    v_mfma_f32_16x16x32_bf16 v[8:11], v[128:131], v[40:43], v[8:11]
    ds_read_b128 v[112:115], v146 offset:16384
    ds_read_b128 v[116:119], v146 offset:18432
    v_mfma_f32_16x16x32_bf16 v[12:15], v[132:135], v[40:43], v[12:15]
    ds_read_b128 v[120:123], v146 offset:20480
    ds_read_b128 v[124:127], v146 offset:22528
    v_mfma_f32_16x16x32_bf16 v[16:19], v[136:139], v[40:43], v[16:19]
    s_waitcnt vmcnt(16)
    v_mfma_f32_16x16x32_bf16 v[20:23], v[140:143], v[40:43], v[20:23]
    v_mfma_f32_16x16x32_bf16 v[36:39], v[140:143], v[44:47], v[36:39]
    v_mfma_f32_16x16x32_bf16 v[32:35], v[136:139], v[44:47], v[32:35]
    v_mfma_f32_16x16x32_bf16 v[28:31], v[132:135], v[44:47], v[28:31]
    s_waitcnt vmcnt(15) lgkmcnt(0)
    v_mfma_f32_16x16x32_bf16 v[24:27], v[128:131], v[44:47], v[24:27]
    v_mfma_f32_16x16x32_bf16 v[8:11], v[112:115], v[48:51], v[8:11]
    ds_read_b128 v[128:131], v147 offset:16384
    ds_read_b128 v[132:135], v147 offset:18432
    v_mfma_f32_16x16x32_bf16 v[12:15], v[116:119], v[48:51], v[12:15]
    ds_read_b128 v[136:139], v147 offset:20480
    ds_read_b128 v[140:143], v147 offset:22528
    v_mfma_f32_16x16x32_bf16 v[16:19], v[120:123], v[48:51], v[16:19]
    s_waitcnt vmcnt(14)
    ds_read_b32 v6, v167 offset:520
    v_mfma_f32_16x16x32_bf16 v[20:23], v[124:127], v[48:51], v[20:23]
    v_mfma_f32_16x16x32_bf16 v[36:39], v[124:127], v[52:55], v[36:39]
    v_mfma_f32_16x16x32_bf16 v[32:35], v[120:123], v[52:55], v[32:35]
    v_mfma_f32_16x16x32_bf16 v[28:31], v[116:119], v[52:55], v[28:31]
    s_waitcnt vmcnt(13) lgkmcnt(0)
    v_readfirstlane_b32 s4, v6
    v_mfma_f32_16x16x32_bf16 v[24:27], v[112:115], v[52:55], v[24:27]
    s_andn2_b32 s4, 0x40000, s4
    s_cbranch_scc1 s1_slowNN10
s1_backNN10:
    v_mfma_f32_16x16x32_bf16 v[8:11], v[128:131], v[56:59], v[8:11]
    ds_read_b128 v[112:115], v148 offset:0
    ds_read_b128 v[116:119], v148 offset:2048
    v_mfma_f32_16x16x32_bf16 v[12:15], v[132:135], v[56:59], v[12:15]
    ds_read_b128 v[120:123], v148 offset:4096
    ds_read_b128 v[124:127], v148 offset:6144
    v_mfma_f32_16x16x32_bf16 v[16:19], v[136:139], v[56:59], v[16:19]
    s_waitcnt vmcnt(12)
    v_mfma_f32_16x16x32_bf16 v[20:23], v[140:143], v[56:59], v[20:23]
    v_mfma_f32_16x16x32_bf16 v[36:39], v[140:143], v[60:63], v[36:39]
    v_mfma_f32_16x16x32_bf16 v[32:35], v[136:139], v[60:63], v[32:35]
    v_mfma_f32_16x16x32_bf16 v[28:31], v[132:135], v[60:63], v[28:31]
    s_waitcnt vmcnt(11) lgkmcnt(0)
    v_mfma_f32_16x16x32_bf16 v[24:27], v[128:131], v[60:63], v[24:27]
    v_mfma_f32_16x16x32_bf16 v[8:11], v[112:115], v[64:67], v[8:11]
    ds_read_b128 v[128:131], v149 offset:0
    ds_read_b128 v[132:135], v149 offset:2048
    v_mfma_f32_16x16x32_bf16 v[12:15], v[116:119], v[64:67], v[12:15]
    ds_read_b128 v[136:139], v149 offset:4096
    ds_read_b128 v[140:143], v149 offset:6144
    v_mfma_f32_16x16x32_bf16 v[16:19], v[120:123], v[64:67], v[16:19]
    s_waitcnt vmcnt(10)
    v_mfma_f32_16x16x32_bf16 v[20:23], v[124:127], v[64:67], v[20:23]
    v_mfma_f32_16x16x32_bf16 v[36:39], v[124:127], v[68:71], v[36:39]
    v_mfma_f32_16x16x32_bf16 v[32:35], v[120:123], v[68:71], v[32:35]
    v_mfma_f32_16x16x32_bf16 v[28:31], v[116:119], v[68:71], v[28:31]
    s_waitcnt vmcnt(9) lgkmcnt(0)
    v_mfma_f32_16x16x32_bf16 v[24:27], v[112:115], v[68:71], v[24:27]
    v_mfma_f32_16x16x32_bf16 v[8:11], v[128:131], v[72:75], v[8:11]
    ds_read_b128 v[112:115], v148 offset:8192
    ds_read_b128 v[116:119], v148 offset:10240
    v_mfma_f32_16x16x32_bf16 v[12:15], v[132:135], v[72:75], v[12:15]
    ds_read_b128 v[120:123], v148 offset:12288
    ds_read_b128 v[124:127], v148 offset:14336
    v_mfma_f32_16x16x32_bf16 v[16:19], v[136:139], v[72:75], v[16:19]
    s_waitcnt vmcnt(8)
    v_mfma_f32_16x16x32_bf16 v[20:23], v[140:143], v[72:75], v[20:23]
    v_mfma_f32_16x16x32_bf16 v[36:39], v[140:143], v[76:79], v[36:39]
    v_mfma_f32_16x16x32_bf16 v[32:35], v[136:139], v[76:79], v[32:35]
    v_mfma_f32_16x16x32_bf16 v[28:31], v[132:135], v[76:79], v[28:31]
    s_waitcnt vmcnt(7) lgkmcnt(0)
    v_mfma_f32_16x16x32_bf16 v[24:27], v[128:131], v[76:79], v[24:27]
    v_mfma_f32_16x16x32_bf16 v[8:11], v[112:115], v[80:83], v[8:11]
    ds_read_b128 v[128:131], v149 offset:8192
    ds_read_b128 v[132:135], v149 offset:10240
    v_mfma_f32_16x16x32_bf16 v[12:15], v[116:119], v[80:83], v[12:15]
    ds_read_b128 v[136:139], v149 offset:12288
    ds_read_b128 v[140:143], v149 offset:14336
    v_mfma_f32_16x16x32_bf16 v[16:19], v[120:123], v[80:83], v[16:19]
    s_waitcnt vmcnt(6)
    v_mfma_f32_16x16x32_bf16 v[20:23], v[124:127], v[80:83], v[20:23]
    v_mfma_f32_16x16x32_bf16 v[36:39], v[124:127], v[84:87], v[36:39]
    v_mfma_f32_16x16x32_bf16 v[32:35], v[120:123], v[84:87], v[32:35]
    v_mfma_f32_16x16x32_bf16 v[28:31], v[116:119], v[84:87], v[28:31]
    s_waitcnt vmcnt(5) lgkmcnt(0)
    v_mfma_f32_16x16x32_bf16 v[24:27], v[112:115], v[84:87], v[24:27]
    v_mfma_f32_16x16x32_bf16 v[8:11], v[128:131], v[88:91], v[8:11]
    ds_read_b128 v[112:115], v148 offset:16384
    ds_read_b128 v[116:119], v148 offset:18432
    v_mfma_f32_16x16x32_bf16 v[12:15], v[132:135], v[88:91], v[12:15]
    ds_read_b128 v[120:123], v148 offset:20480
    ds_read_b128 v[124:127], v148 offset:22528
    v_mfma_f32_16x16x32_bf16 v[16:19], v[136:139], v[88:91], v[16:19]
    s_waitcnt vmcnt(4)
    v_mfma_f32_16x16x32_bf16 v[20:23], v[140:143], v[88:91], v[20:23]
    v_mfma_f32_16x16x32_bf16 v[36:39], v[140:143], v[92:95], v[36:39]
    v_mfma_f32_16x16x32_bf16 v[32:35], v[136:139], v[92:95], v[32:35]
    v_mfma_f32_16x16x32_bf16 v[28:31], v[132:135], v[92:95], v[28:31]
    s_waitcnt vmcnt(3) lgkmcnt(0)
    v_mfma_f32_16x16x32_bf16 v[24:27], v[128:131], v[92:95], v[24:27]
    v_mfma_f32_16x16x32_bf16 v[8:11], v[112:115], v[96:99], v[8:11]
    ds_read_b128 v[128:131], v149 offset:16384
    ds_read_b128 v[132:135], v149 offset:18432
    v_mfma_f32_16x16x32_bf16 v[12:15], v[116:119], v[96:99], v[12:15]
    ds_read_b128 v[136:139], v149 offset:20480
    ds_read_b128 v[140:143], v149 offset:22528
    v_mfma_f32_16x16x32_bf16 v[16:19], v[120:123], v[96:99], v[16:19]
    s_waitcnt vmcnt(2)
    v_mfma_f32_16x16x32_bf16 v[20:23], v[124:127], v[96:99], v[20:23]
    v_mfma_f32_16x16x32_bf16 v[36:39], v[124:127], v[100:103], v[36:39]
    v_mfma_f32_16x16x32_bf16 v[32:35], v[120:123], v[100:103], v[32:35]
    v_mfma_f32_16x16x32_bf16 v[28:31], v[116:119], v[100:103], v[28:31]
    s_waitcnt vmcnt(1) lgkmcnt(0)
    v_mfma_f32_16x16x32_bf16 v[24:27], v[112:115], v[100:103], v[24:27]
    v_mfma_f32_16x16x32_bf16 v[8:11], v[128:131], v[104:107], v[8:11]
    v_mfma_f32_16x16x32_bf16 v[12:15], v[132:135], v[104:107], v[12:15]
    v_mfma_f32_16x16x32_bf16 v[16:19], v[136:139], v[104:107], v[16:19]
    s_waitcnt vmcnt(0)
    v_mfma_f32_16x16x32_bf16 v[20:23], v[140:143], v[104:107], v[20:23]
    v_mfma_f32_16x16x32_bf16 v[36:39], v[140:143], v[108:111], v[36:39]
    v_mfma_f32_16x16x32_bf16 v[32:35], v[136:139], v[108:111], v[32:35]
    v_mfma_f32_16x16x32_bf16 v[28:31], v[132:135], v[108:111], v[28:31]
    v_mfma_f32_16x16x32_bf16 v[24:27], v[128:131], v[108:111], v[24:27]
    s_mov_b32 s5, 0
s1_sNN:
    ds_read_b32 v6, v167 offset:512
    s_waitcnt lgkmcnt(0)
    v_readfirstlane_b32 s4, v6
    s_nop 0
    s_and_b32 s4, s4, 0x2
    s_cmp_eq_u32 s4, 0x2
    s_cbranch_scc1 s1_sNN_ok
    s_sleep 1
    s_add_u32 s5, s5, 1
    s_cmp_lt_u32 s5, 0x40000
    s_cbranch_scc1 s1_sNN
    s_endpgm
s1_sNN_ok:
    v_lshlrev_b32 v6, 4, v3
    ds_read_b128 v[40:43], v6 offset:0
    ds_read_b128 v[44:47], v6 offset:64
    ds_read_b128 v[48:51], v6 offset:128
    ds_read_b128 v[52:55], v6 offset:192
    ds_read_b128 v[56:59], v6 offset:256
    ds_read_b128 v[60:63], v6 offset:320
    ds_read_b128 v[64:67], v6 offset:384
    ds_read_b128 v[68:71], v6 offset:448
    v_mov_b32 v104, 0x3f803f80
    v_mov_b32 v105, 0x3f803f80
    v_mov_b32 v106, 0x3f803f80
    v_mov_b32 v107, 0x3f803f80
    s_lshl_b32 s4, s13, 2
    s_add_u32 s4, s4, s20
    s_mul_i32 s6, s4, 1536
    s_add_u32 s6, s6, s96
    s_waitcnt lgkmcnt(0)
    v_mul_f32 v72, v8, v56
    v_mul_f32 v73, v9, v57
    v_mul_f32 v74, v10, v58
    v_mul_f32 v75, v11, v59
    v_mul_f32 v76, v12, v60
    v_mul_f32 v77, v13, v61
    v_mul_f32 v78, v14, v62
    v_mul_f32 v79, v15, v63
    v_min_f32 v72, 0, v72
    v_min_f32 v73, 0, v73
    v_min_f32 v74, 0, v74
    v_min_f32 v75, 0, v75
    v_min_f32 v76, 0, v76
    v_min_f32 v77, 0, v77
    v_min_f32 v78, 0, v78
    v_min_f32 v79, 0, v79
    v_exp_f32 v72, v72
    v_exp_f32 v73, v73
    v_exp_f32 v74, v74
    v_exp_f32 v75, v75
    v_exp_f32 v76, v76
    v_exp_f32 v77, v77
    v_exp_f32 v78, v78
    v_exp_f32 v79, v79
    v_max_f32 v8, 0, v8
    v_max_f32 v9, 0, v9
    v_max_f32 v10, 0, v10
    v_max_f32 v11, 0, v11
    v_max_f32 v12, 0, v12
    v_max_f32 v13, 0, v13
    v_max_f32 v14, 0, v14
    v_max_f32 v15, 0, v15
    v_add_f32 v72, 0x358637bd, v72
    v_add_f32 v73, 0x358637bd, v73
    v_add_f32 v74, 0x358637bd, v74
    v_add_f32 v75, 0x358637bd, v75
    v_add_f32 v76, 0x358637bd, v76
    v_add_f32 v77, 0x358637bd, v77
    v_add_f32 v78, 0x358637bd, v78
    v_add_f32 v79, 0x358637bd, v79
    v_fma_f32 v8, v8, v40, v72
    v_fma_f32 v9, v9, v41, v73
    v_fma_f32 v10, v10, v42, v74
    v_fma_f32 v11, v11, v43, v75
    v_fma_f32 v12, v12, v44, v76
    v_fma_f32 v13, v13, v45, v77
    v_fma_f32 v14, v14, v46, v78
    v_fma_f32 v15, v15, v47, v79
    v_mul_f32 v24, v24, v40
    v_mul_f32 v25, v25, v41
    v_mul_f32 v26, v26, v42
    v_mul_f32 v27, v27, v43
    v_cvt_pk_bf16_f32 v88, v8, v9
    v_cvt_pk_bf16_f32 v89, v10, v11
    v_cvt_pk_bf16_f32 v96, v24, v25
    v_cvt_pk_bf16_f32 v97, v26, v27
    v_mul_f32 v28, v28, v44
    v_mul_f32 v29, v29, v45
    v_mul_f32 v30, v30, v46
    v_mul_f32 v31, v31, v47
    v_cvt_pk_bf16_f32 v90, v12, v13
    v_cvt_pk_bf16_f32 v91, v14, v15
    v_cvt_pk_bf16_f32 v98, v28, v29
    v_cvt_pk_bf16_f32 v99, v30, v31
    s_nop 1
    v_mfma_f32_16x16x32_bf16 v[112:115], v[96:99], v[88:91], 0
    v_mfma_f32_16x16x32_bf16 v[116:119], v[104:107], v[88:91], 0
    v_mul_f32 v72, v16, v64
    v_mul_f32 v73, v17, v65
    v_mul_f32 v74, v18, v66
    v_mul_f32 v75, v19, v67
    v_mul_f32 v76, v20, v68
    v_mul_f32 v77, v21, v69
    v_mul_f32 v78, v22, v70
    v_mul_f32 v79, v23, v71
    v_min_f32 v72, 0, v72
    v_min_f32 v73, 0, v73
    v_min_f32 v74, 0, v74
    v_min_f32 v75, 0, v75
    v_min_f32 v76, 0, v76
    v_min_f32 v77, 0, v77
    v_min_f32 v78, 0, v78
    v_min_f32 v79, 0, v79
    v_exp_f32 v72, v72
    v_exp_f32 v73, v73
    v_exp_f32 v74, v74
    v_exp_f32 v75, v75
    v_exp_f32 v76, v76
    v_exp_f32 v77, v77
    v_exp_f32 v78, v78
    v_exp_f32 v79, v79
    v_max_f32 v16, 0, v16
    v_max_f32 v17, 0, v17
    v_max_f32 v18, 0, v18
    v_max_f32 v19, 0, v19
    v_max_f32 v20, 0, v20
    v_max_f32 v21, 0, v21
    v_max_f32 v22, 0, v22
    v_max_f32 v23, 0, v23
    v_add_f32 v72, 0x358637bd, v72
    v_add_f32 v73, 0x358637bd, v73
    v_add_f32 v74, 0x358637bd, v74
    v_add_f32 v75, 0x358637bd, v75
    v_add_f32 v76, 0x358637bd, v76
    v_add_f32 v77, 0x358637bd, v77
    v_add_f32 v78, 0x358637bd, v78
    v_add_f32 v79, 0x358637bd, v79
    v_fma_f32 v16, v16, v48, v72
    v_fma_f32 v17, v17, v49, v73
    v_fma_f32 v18, v18, v50, v74
    v_fma_f32 v19, v19, v51, v75
    v_fma_f32 v20, v20, v52, v76
    v_fma_f32 v21, v21, v53, v77
    v_fma_f32 v22, v22, v54, v78
    v_fma_f32 v23, v23, v55, v79
    v_mul_f32 v32, v32, v48
    v_mul_f32 v33, v33, v49
    v_mul_f32 v34, v34, v50
    v_mul_f32 v35, v35, v51
    v_cvt_pk_bf16_f32 v92, v16, v17
    v_cvt_pk_bf16_f32 v93, v18, v19
    v_cvt_pk_bf16_f32 v100, v32, v33
    v_cvt_pk_bf16_f32 v101, v34, v35
    v_mul_f32 v36, v36, v52
    v_mul_f32 v37, v37, v53
    v_mul_f32 v38, v38, v54
    v_mul_f32 v39, v39, v55
    v_cvt_pk_bf16_f32 v94, v20, v21
    v_cvt_pk_bf16_f32 v95, v22, v23
    v_cvt_pk_bf16_f32 v102, v36, v37
    v_cvt_pk_bf16_f32 v103, v38, v39
    s_nop 1
    v_mfma_f32_16x16x32_bf16 v[112:115], v[100:103], v[92:95], v[112:115]
    v_mfma_f32_16x16x32_bf16 v[116:119], v[104:107], v[92:95], v[116:119]
    v_and_b32 v4, 0x380, v1
    v_and_b32 v5, 4, v2
    v_lshl_add_u32 v4, v5, 2, v4
    s_lshl_b32 s5, s20, 5
    v_add_u32 v4, s5, v4
    v_lshlrev_b32 v5, 2, v0
    s_nop 0
    buffer_atomic_add_f32 v112, v5, s[8:11], s6 offen offset:0
    buffer_atomic_add_f32 v113, v5, s[8:11], s6 offen offset:256
    buffer_atomic_add_f32 v114, v5, s[8:11], s6 offen offset:512
    buffer_atomic_add_f32 v115, v5, s[8:11], s6 offen offset:768
    s_mov_b64 exec, 0xffff
    buffer_atomic_add_f32 v116, v5, s[8:11], s6 offen offset:1152
    s_mov_b64 exec, -1
    s_mov_b32 s5, 0
s1_w:
    ds_read_b32 v6, v167 offset:512
    s_waitcnt lgkmcnt(0)
    v_readfirstlane_b32 s4, v6
    s_nop 0
    s_and_b32 s4, s4, 0x1
    s_cmp_eq_u32 s4, 0x1
    s_cbranch_scc1 s1_w_ok
    s_sleep 1
    s_add_u32 s5, s5, 1
    s_cmp_lt_u32 s5, 0x40000
    s_cbranch_scc1 s1_w
    s_endpgm
s1_w_ok:
    ds_read_b128 v[128:131], v4 offset:1024
    ds_read_b128 v[132:135], v4 offset:2048
    v_lshlrev_b32 v6, 3, v2
    v_lshl_add_u32 v6, v3, 2, v6
    v_add_u32 v6, 384, v6
    s_mov_b32 s40, -1
    s_mov_b32 s41, 0
    v_cndmask_b32 v6, v5, v6, s[40:41]
    s_waitcnt lgkmcnt(0)
    v_mfma_f32_16x16x32_bf16 v[120:123], v[128:131], v[96:99], 0
    v_mfma_f32_16x16x32_bf16 v[124:127], v[128:131], v[88:91], 0
    v_mfma_f32_16x16x32_bf16 v[120:123], v[132:135], v[100:103], v[120:123]
    v_mfma_f32_16x16x32_bf16 v[124:127], v[132:135], v[92:95], v[124:127]
    s_nop 7
    v_cndmask_b32 v120, v124, v120, s[40:41]
    buffer_atomic_add_f32 v120, v6, s[8:11], s6 offen offset:896
    s_branch s1_done
s1_nt:
    s_setprio 2
    s_waitcnt vmcnt(17) lgkmcnt(0)
    v_mfma_f32_16x16x32_bf16 v[8:11], v[112:115], v[40:43], 0
    ds_read_b128 v[128:131], v145 offset:0
    ds_read_b128 v[132:135], v145 offset:2048
    v_mfma_f32_16x16x32_bf16 v[12:15], v[116:119], v[40:43], 0
    ds_read_b128 v[136:139], v145 offset:4096
    ds_read_b128 v[140:143], v145 offset:6144
    v_mfma_f32_16x16x32_bf16 v[16:19], v[120:123], v[40:43], 0
    s_waitcnt vmcnt(16)
    v_mfma_f32_16x16x32_bf16 v[20:23], v[124:127], v[40:43], 0
    buffer_load_dwordx4 v[40:43], v1, s[8:11], s15 offen offset:2048 sc1
    v_mfma_f32_16x16x32_bf16 v[36:39], v[44:47], v[124:127], 0
    v_mfma_f32_16x16x32_bf16 v[32:35], v[44:47], v[120:123], 0
    v_mfma_f32_16x16x32_bf16 v[28:31], v[44:47], v[116:119], 0
    s_waitcnt vmcnt(16) lgkmcnt(0)
    v_mfma_f32_16x16x32_bf16 v[24:27], v[44:47], v[112:115], 0
    buffer_load_dwordx4 v[44:47], v1, s[8:11], s15 offen offset:3072 sc1
    v_mfma_f32_16x16x32_bf16 v[8:11], v[128:131], v[48:51], v[8:11]
    ds_read_b128 v[112:115], v144 offset:8192
    ds_read_b128 v[116:119], v144 offset:10240
    v_mfma_f32_16x16x32_bf16 v[12:15], v[132:135], v[48:51], v[12:15]
    ds_read_b128 v[120:123], v144 offset:12288
    ds_read_b128 v[124:127], v144 offset:14336
    v_mfma_f32_16x16x32_bf16 v[16:19], v[136:139], v[48:51], v[16:19]
    s_waitcnt vmcnt(16)
    v_mfma_f32_16x16x32_bf16 v[20:23], v[140:143], v[48:51], v[20:23]
    s_add_u32 s15, s31, 8192
    buffer_load_dwordx4 v[48:51], v1, s[8:11], s15 offen offset:0 sc1
    v_mfma_f32_16x16x32_bf16 v[36:39], v[52:55], v[140:143], v[36:39]
    v_mfma_f32_16x16x32_bf16 v[32:35], v[52:55], v[136:139], v[32:35]
    v_mfma_f32_16x16x32_bf16 v[28:31], v[52:55], v[132:135], v[28:31]
    s_waitcnt vmcnt(16) lgkmcnt(0)
    v_mfma_f32_16x16x32_bf16 v[24:27], v[52:55], v[128:131], v[24:27]
    buffer_load_dwordx4 v[52:55], v1, s[8:11], s15 offen offset:1024 sc1
    v_mfma_f32_16x16x32_bf16 v[8:11], v[112:115], v[56:59], v[8:11]
    ds_read_b128 v[128:131], v145 offset:8192
    ds_read_b128 v[132:135], v145 offset:10240
    v_mfma_f32_16x16x32_bf16 v[12:15], v[116:119], v[56:59], v[12:15]
    ds_read_b128 v[136:139], v145 offset:12288
    ds_read_b128 v[140:143], v145 offset:14336
    v_mfma_f32_16x16x32_bf16 v[16:19], v[120:123], v[56:59], v[16:19]
    s_waitcnt vmcnt(16)
    v_mfma_f32_16x16x32_bf16 v[20:23], v[124:127], v[56:59], v[20:23]
    buffer_load_dwordx4 v[56:59], v1, s[8:11], s15 offen offset:2048 sc1
    v_mfma_f32_16x16x32_bf16 v[36:39], v[60:63], v[124:127], v[36:39]
    v_mfma_f32_16x16x32_bf16 v[32:35], v[60:63], v[120:123], v[32:35]
    v_mfma_f32_16x16x32_bf16 v[28:31], v[60:63], v[116:119], v[28:31]
    s_waitcnt vmcnt(16) lgkmcnt(0)
    v_mfma_f32_16x16x32_bf16 v[24:27], v[60:63], v[112:115], v[24:27]
    buffer_load_dwordx4 v[60:63], v1, s[8:11], s15 offen offset:3072 sc1
    v_mfma_f32_16x16x32_bf16 v[8:11], v[128:131], v[64:67], v[8:11]
    ds_read_b128 v[112:115], v144 offset:16384
    ds_read_b128 v[116:119], v144 offset:18432
    v_mfma_f32_16x16x32_bf16 v[12:15], v[132:135], v[64:67], v[12:15]
    ds_read_b128 v[120:123], v144 offset:20480
    ds_read_b128 v[124:127], v144 offset:22528
    v_mfma_f32_16x16x32_bf16 v[16:19], v[136:139], v[64:67], v[16:19]
    s_waitcnt vmcnt(16)
    v_mfma_f32_16x16x32_bf16 v[20:23], v[140:143], v[64:67], v[20:23]
    s_add_u32 s15, s32, 0
    buffer_load_dwordx4 v[64:67], v1, s[8:11], s15 offen offset:0 sc1
    v_mfma_f32_16x16x32_bf16 v[36:39], v[68:71], v[140:143], v[36:39]
    v_mfma_f32_16x16x32_bf16 v[32:35], v[68:71], v[136:139], v[32:35]
    v_mfma_f32_16x16x32_bf16 v[28:31], v[68:71], v[132:135], v[28:31]
    s_waitcnt vmcnt(16) lgkmcnt(0)
    v_mfma_f32_16x16x32_bf16 v[24:27], v[68:71], v[128:131], v[24:27]
    buffer_load_dwordx4 v[68:71], v1, s[8:11], s15 offen offset:1024 sc1
    v_mfma_f32_16x16x32_bf16 v[8:11], v[112:115], v[72:75], v[8:11]
    ds_read_b128 v[128:131], v145 offset:16384
    ds_read_b128 v[132:135], v145 offset:18432
    v_mfma_f32_16x16x32_bf16 v[12:15], v[116:119], v[72:75], v[12:15]
    ds_read_b128 v[136:139], v145 offset:20480
    ds_read_b128 v[140:143], v145 offset:22528
    v_mfma_f32_16x16x32_bf16 v[16:19], v[120:123], v[72:75], v[16:19]
    s_waitcnt vmcnt(16)
    ds_read_b32 v6, v167 offset:520
    v_mfma_f32_16x16x32_bf16 v[20:23], v[124:127], v[72:75], v[20:23]
    buffer_load_dwordx4 v[72:75], v1, s[8:11], s15 offen offset:2048 sc1
    v_mfma_f32_16x16x32_bf16 v[36:39], v[76:79], v[124:127], v[36:39]
    v_mfma_f32_16x16x32_bf16 v[32:35], v[76:79], v[120:123], v[32:35]
    v_mfma_f32_16x16x32_bf16 v[28:31], v[76:79], v[116:119], v[28:31]
    s_waitcnt vmcnt(16) lgkmcnt(0)
    v_readfirstlane_b32 s4, v6
    v_mfma_f32_16x16x32_bf16 v[24:27], v[76:79], v[112:115], v[24:27]
    buffer_load_dwordx4 v[76:79], v1, s[8:11], s15 offen offset:3072 sc1
    s_andn2_b32 s4, 0x400, s4
    s_cbranch_scc1 s1_slowNT4
s1_backNT4:
    v_mfma_f32_16x16x32_bf16 v[8:11], v[128:131], v[80:83], v[8:11]
    ds_read_b128 v[112:115], v146 offset:0
    ds_read_b128 v[116:119], v146 offset:2048
    v_mfma_f32_16x16x32_bf16 v[12:15], v[132:135], v[80:83], v[12:15]
    ds_read_b128 v[120:123], v146 offset:4096
    ds_read_b128 v[124:127], v146 offset:6144
    v_mfma_f32_16x16x32_bf16 v[16:19], v[136:139], v[80:83], v[16:19]
    s_waitcnt vmcnt(16)
    v_mfma_f32_16x16x32_bf16 v[20:23], v[140:143], v[80:83], v[20:23]
    s_add_u32 s15, s32, 4096
    buffer_load_dwordx4 v[80:83], v1, s[8:11], s15 offen offset:0 sc1
    v_mfma_f32_16x16x32_bf16 v[36:39], v[84:87], v[140:143], v[36:39]
    v_mfma_f32_16x16x32_bf16 v[32:35], v[84:87], v[136:139], v[32:35]
    v_mfma_f32_16x16x32_bf16 v[28:31], v[84:87], v[132:135], v[28:31]
    s_waitcnt vmcnt(16) lgkmcnt(0)
    v_mfma_f32_16x16x32_bf16 v[24:27], v[84:87], v[128:131], v[24:27]
    buffer_load_dwordx4 v[84:87], v1, s[8:11], s15 offen offset:1024 sc1
    v_mfma_f32_16x16x32_bf16 v[8:11], v[112:115], v[88:91], v[8:11]
    ds_read_b128 v[128:131], v147 offset:0
    ds_read_b128 v[132:135], v147 offset:2048
    v_mfma_f32_16x16x32_bf16 v[12:15], v[116:119], v[88:91], v[12:15]
    ds_read_b128 v[136:139], v147 offset:4096
    ds_read_b128 v[140:143], v147 offset:6144
    v_mfma_f32_16x16x32_bf16 v[16:19], v[120:123], v[88:91], v[16:19]
    s_waitcnt vmcnt(16)
    v_mfma_f32_16x16x32_bf16 v[20:23], v[124:127], v[88:91], v[20:23]
    buffer_load_dwordx4 v[88:91], v1, s[8:11], s15 offen offset:2048 sc1
    v_mfma_f32_16x16x32_bf16 v[36:39], v[92:95], v[124:127], v[36:39]
    v_mfma_f32_16x16x32_bf16 v[32:35], v[92:95], v[120:123], v[32:35]
    v_mfma_f32_16x16x32_bf16 v[28:31], v[92:95], v[116:119], v[28:31]
    s_waitcnt vmcnt(16) lgkmcnt(0)
    v_mfma_f32_16x16x32_bf16 v[24:27], v[92:95], v[112:115], v[24:27]
    buffer_load_dwordx4 v[92:95], v1, s[8:11], s15 offen offset:3072 sc1
    v_mfma_f32_16x16x32_bf16 v[8:11], v[128:131], v[96:99], v[8:11]
    ds_read_b128 v[112:115], v146 offset:8192
    ds_read_b128 v[116:119], v146 offset:10240
    v_mfma_f32_16x16x32_bf16 v[12:15], v[132:135], v[96:99], v[12:15]
    ds_read_b128 v[120:123], v146 offset:12288
    ds_read_b128 v[124:127], v146 offset:14336
    v_mfma_f32_16x16x32_bf16 v[16:19], v[136:139], v[96:99], v[16:19]
    s_waitcnt vmcnt(16)
    v_mfma_f32_16x16x32_bf16 v[20:23], v[140:143], v[96:99], v[20:23]
    s_add_u32 s15, s32, 8192
    buffer_load_dwordx4 v[96:99], v1, s[8:11], s15 offen offset:0 sc1
    v_mfma_f32_16x16x32_bf16 v[36:39], v[100:103], v[140:143], v[36:39]
    v_mfma_f32_16x16x32_bf16 v[32:35], v[100:103], v[136:139], v[32:35]
    v_mfma_f32_16x16x32_bf16 v[28:31], v[100:103], v[132:135], v[28:31]
    s_waitcnt vmcnt(16) lgkmcnt(0)
    v_mfma_f32_16x16x32_bf16 v[24:27], v[100:103], v[128:131], v[24:27]
    buffer_load_dwordx4 v[100:103], v1, s[8:11], s15 offen offset:1024 sc1
    v_mfma_f32_16x16x32_bf16 v[8:11], v[112:115], v[104:107], v[8:11]
    ds_read_b128 v[128:131], v147 offset:8192
    ds_read_b128 v[132:135], v147 offset:10240
    v_mfma_f32_16x16x32_bf16 v[12:15], v[116:119], v[104:107], v[12:15]
    ds_read_b128 v[136:139], v147 offset:12288
    ds_read_b128 v[140:143], v147 offset:14336
    v_mfma_f32_16x16x32_bf16 v[16:19], v[120:123], v[104:107], v[16:19]
    s_waitcnt vmcnt(16)
    v_mfma_f32_16x16x32_bf16 v[20:23], v[124:127], v[104:107], v[20:23]
    buffer_load_dwordx4 v[104:107], v1, s[8:11], s15 offen offset:2048 sc1
    v_mfma_f32_16x16x32_bf16 v[36:39], v[108:111], v[124:127], v[36:39]
    s_mov_b64 exec, 1
    ds_add_u32 v167, v7 offset:520
    s_mov_b64 exec, -1
    v_mfma_f32_16x16x32_bf16 v[32:35], v[108:111], v[120:123], v[32:35]
    v_mfma_f32_16x16x32_bf16 v[28:31], v[108:111], v[116:119], v[28:31]
    s_waitcnt vmcnt(16) lgkmcnt(0)
    v_mfma_f32_16x16x32_bf16 v[24:27], v[108:111], v[112:115], v[24:27]
    buffer_load_dwordx4 v[108:111], v1, s[8:11], s15 offen offset:3072 sc1
    v_mfma_f32_16x16x32_bf16 v[8:11], v[128:131], v[40:43], v[8:11]
    ds_read_b128 v[112:115], v146 offset:16384
    ds_read_b128 v[116:119], v146 offset:18432
    v_mfma_f32_16x16x32_bf16 v[12:15], v[132:135], v[40:43], v[12:15]
    ds_read_b128 v[120:123], v146 offset:20480
    ds_read_b128 v[124:127], v146 offset:22528
    v_mfma_f32_16x16x32_bf16 v[16:19], v[136:139], v[40:43], v[16:19]
    s_waitcnt vmcnt(16)
    v_mfma_f32_16x16x32_bf16 v[20:23], v[140:143], v[40:43], v[20:23]
    v_mfma_f32_16x16x32_bf16 v[36:39], v[44:47], v[140:143], v[36:39]
    v_mfma_f32_16x16x32_bf16 v[32:35], v[44:47], v[136:139], v[32:35]
    v_mfma_f32_16x16x32_bf16 v[28:31], v[44:47], v[132:135], v[28:31]
    s_waitcnt vmcnt(15) lgkmcnt(0)
    v_mfma_f32_16x16x32_bf16 v[24:27], v[44:47], v[128:131], v[24:27]
    v_mfma_f32_16x16x32_bf16 v[8:11], v[112:115], v[48:51], v[8:11]
    ds_read_b128 v[128:131], v147 offset:16384
    ds_read_b128 v[132:135], v147 offset:18432
    v_mfma_f32_16x16x32_bf16 v[12:15], v[116:119], v[48:51], v[12:15]
    ds_read_b128 v[136:139], v147 offset:20480
    ds_read_b128 v[140:143], v147 offset:22528
    v_mfma_f32_16x16x32_bf16 v[16:19], v[120:123], v[48:51], v[16:19]
    s_waitcnt vmcnt(14)
    ds_read_b32 v6, v167 offset:520
    v_mfma_f32_16x16x32_bf16 v[20:23], v[124:127], v[48:51], v[20:23]
    v_mfma_f32_16x16x32_bf16 v[36:39], v[52:55], v[124:127], v[36:39]
    v_mfma_f32_16x16x32_bf16 v[32:35], v[52:55], v[120:123], v[32:35]
    v_mfma_f32_16x16x32_bf16 v[28:31], v[52:55], v[116:119], v[28:31]
    s_waitcnt vmcnt(13) lgkmcnt(0)
    v_readfirstlane_b32 s4, v6
    v_mfma_f32_16x16x32_bf16 v[24:27], v[52:55], v[112:115], v[24:27]
    s_andn2_b32 s4, 0x40000, s4
    s_cbranch_scc1 s1_slowNT10
s1_backNT10:
    v_mfma_f32_16x16x32_bf16 v[8:11], v[128:131], v[56:59], v[8:11]
    ds_read_b128 v[112:115], v148 offset:0
    ds_read_b128 v[116:119], v148 offset:2048
    v_mfma_f32_16x16x32_bf16 v[12:15], v[132:135], v[56:59], v[12:15]
    ds_read_b128 v[120:123], v148 offset:4096
    ds_read_b128 v[124:127], v148 offset:6144
    v_mfma_f32_16x16x32_bf16 v[16:19], v[136:139], v[56:59], v[16:19]
    s_waitcnt vmcnt(12)
    v_mfma_f32_16x16x32_bf16 v[20:23], v[140:143], v[56:59], v[20:23]
    v_mfma_f32_16x16x32_bf16 v[36:39], v[60:63], v[140:143], v[36:39]
    v_mfma_f32_16x16x32_bf16 v[32:35], v[60:63], v[136:139], v[32:35]
    v_mfma_f32_16x16x32_bf16 v[28:31], v[60:63], v[132:135], v[28:31]
    s_waitcnt vmcnt(11) lgkmcnt(0)
    v_mfma_f32_16x16x32_bf16 v[24:27], v[60:63], v[128:131], v[24:27]
    v_mfma_f32_16x16x32_bf16 v[8:11], v[112:115], v[64:67], v[8:11]
    ds_read_b128 v[128:131], v149 offset:0
    ds_read_b128 v[132:135], v149 offset:2048
    v_mfma_f32_16x16x32_bf16 v[12:15], v[116:119], v[64:67], v[12:15]
    ds_read_b128 v[136:139], v149 offset:4096
    ds_read_b128 v[140:143], v149 offset:6144
    v_mfma_f32_16x16x32_bf16 v[16:19], v[120:123], v[64:67], v[16:19]
    s_waitcnt vmcnt(10)
    v_mfma_f32_16x16x32_bf16 v[20:23], v[124:127], v[64:67], v[20:23]
    v_mfma_f32_16x16x32_bf16 v[36:39], v[68:71], v[124:127], v[36:39]
    v_mfma_f32_16x16x32_bf16 v[32:35], v[68:71], v[120:123], v[32:35]
    v_mfma_f32_16x16x32_bf16 v[28:31], v[68:71], v[116:119], v[28:31]
    s_waitcnt vmcnt(9) lgkmcnt(0)
    v_mfma_f32_16x16x32_bf16 v[24:27], v[68:71], v[112:115], v[24:27]
    v_mfma_f32_16x16x32_bf16 v[8:11], v[128:131], v[72:75], v[8:11]
    ds_read_b128 v[112:115], v148 offset:8192
    ds_read_b128 v[116:119], v148 offset:10240
    v_mfma_f32_16x16x32_bf16 v[12:15], v[132:135], v[72:75], v[12:15]
    ds_read_b128 v[120:123], v148 offset:12288
    ds_read_b128 v[124:127], v148 offset:14336
    v_mfma_f32_16x16x32_bf16 v[16:19], v[136:139], v[72:75], v[16:19]
    s_waitcnt vmcnt(8)
    v_mfma_f32_16x16x32_bf16 v[20:23], v[140:143], v[72:75], v[20:23]
    v_mfma_f32_16x16x32_bf16 v[36:39], v[76:79], v[140:143], v[36:39]
    v_mfma_f32_16x16x32_bf16 v[32:35], v[76:79], v[136:139], v[32:35]
    v_mfma_f32_16x16x32_bf16 v[28:31], v[76:79], v[132:135], v[28:31]
    s_waitcnt vmcnt(7) lgkmcnt(0)
    v_mfma_f32_16x16x32_bf16 v[24:27], v[76:79], v[128:131], v[24:27]
    v_mfma_f32_16x16x32_bf16 v[8:11], v[112:115], v[80:83], v[8:11]
    ds_read_b128 v[128:131], v149 offset:8192
    ds_read_b128 v[132:135], v149 offset:10240
    v_mfma_f32_16x16x32_bf16 v[12:15], v[116:119], v[80:83], v[12:15]
    ds_read_b128 v[136:139], v149 offset:12288
    ds_read_b128 v[140:143], v149 offset:14336
    v_mfma_f32_16x16x32_bf16 v[16:19], v[120:123], v[80:83], v[16:19]
    s_waitcnt vmcnt(6)
    v_mfma_f32_16x16x32_bf16 v[20:23], v[124:127], v[80:83], v[20:23]
    v_mfma_f32_16x16x32_bf16 v[36:39], v[84:87], v[124:127], v[36:39]
    v_mfma_f32_16x16x32_bf16 v[32:35], v[84:87], v[120:123], v[32:35]
    v_mfma_f32_16x16x32_bf16 v[28:31], v[84:87], v[116:119], v[28:31]
    s_waitcnt vmcnt(5) lgkmcnt(0)
    v_mfma_f32_16x16x32_bf16 v[24:27], v[84:87], v[112:115], v[24:27]
    v_mfma_f32_16x16x32_bf16 v[8:11], v[128:131], v[88:91], v[8:11]
    ds_read_b128 v[112:115], v148 offset:16384
    ds_read_b128 v[116:119], v148 offset:18432
    v_mfma_f32_16x16x32_bf16 v[12:15], v[132:135], v[88:91], v[12:15]
    ds_read_b128 v[120:123], v148 offset:20480
    ds_read_b128 v[124:127], v148 offset:22528
    v_mfma_f32_16x16x32_bf16 v[16:19], v[136:139], v[88:91], v[16:19]
    s_waitcnt vmcnt(4)
    v_mfma_f32_16x16x32_bf16 v[20:23], v[140:143], v[88:91], v[20:23]
    v_mfma_f32_16x16x32_bf16 v[36:39], v[92:95], v[140:143], v[36:39]
    v_mfma_f32_16x16x32_bf16 v[32:35], v[92:95], v[136:139], v[32:35]
    v_mfma_f32_16x16x32_bf16 v[28:31], v[92:95], v[132:135], v[28:31]
    s_waitcnt vmcnt(3) lgkmcnt(0)
    v_mfma_f32_16x16x32_bf16 v[24:27], v[92:95], v[128:131], v[24:27]
    v_mfma_f32_16x16x32_bf16 v[8:11], v[112:115], v[96:99], v[8:11]
    ds_read_b128 v[128:131], v149 offset:16384
    ds_read_b128 v[132:135], v149 offset:18432
    v_mfma_f32_16x16x32_bf16 v[12:15], v[116:119], v[96:99], v[12:15]
    ds_read_b128 v[136:139], v149 offset:20480
    ds_read_b128 v[140:143], v149 offset:22528
    v_mfma_f32_16x16x32_bf16 v[16:19], v[120:123], v[96:99], v[16:19]
    s_waitcnt vmcnt(2)
    v_mfma_f32_16x16x32_bf16 v[20:23], v[124:127], v[96:99], v[20:23]
    v_mfma_f32_16x16x32_bf16 v[36:39], v[100:103], v[124:127], v[36:39]
    v_mfma_f32_16x16x32_bf16 v[32:35], v[100:103], v[120:123], v[32:35]
    v_mfma_f32_16x16x32_bf16 v[28:31], v[100:103], v[116:119], v[28:31]
    s_waitcnt vmcnt(1) lgkmcnt(0)
    v_mfma_f32_16x16x32_bf16 v[24:27], v[100:103], v[112:115], v[24:27]
    v_mfma_f32_16x16x32_bf16 v[8:11], v[128:131], v[104:107], v[8:11]
    v_mfma_f32_16x16x32_bf16 v[12:15], v[132:135], v[104:107], v[12:15]
    v_mfma_f32_16x16x32_bf16 v[16:19], v[136:139], v[104:107], v[16:19]
    s_waitcnt vmcnt(0)
    v_mfma_f32_16x16x32_bf16 v[20:23], v[140:143], v[104:107], v[20:23]
    v_mfma_f32_16x16x32_bf16 v[36:39], v[108:111], v[140:143], v[36:39]
    v_mfma_f32_16x16x32_bf16 v[32:35], v[108:111], v[136:139], v[32:35]
    v_mfma_f32_16x16x32_bf16 v[28:31], v[108:111], v[132:135], v[28:31]
    v_mfma_f32_16x16x32_bf16 v[24:27], v[108:111], v[128:131], v[24:27]
    s_mov_b32 s5, 0
s1_sNT:
    ds_read_b32 v6, v167 offset:512
    s_waitcnt lgkmcnt(0)
    v_readfirstlane_b32 s4, v6
    s_nop 0
    s_and_b32 s4, s4, 0x2
    s_cmp_eq_u32 s4, 0x2
    s_cbranch_scc1 s1_sNT_ok
    s_sleep 1
    s_add_u32 s5, s5, 1
    s_cmp_lt_u32 s5, 0x40000
    s_cbranch_scc1 s1_sNT
    s_endpgm
s1_sNT_ok:
    v_lshlrev_b32 v6, 4, v3
    ds_read_b128 v[40:43], v6 offset:0
    ds_read_b128 v[44:47], v6 offset:64
    ds_read_b128 v[48:51], v6 offset:128
    ds_read_b128 v[52:55], v6 offset:192
    ds_read_b128 v[56:59], v6 offset:256
    ds_read_b128 v[60:63], v6 offset:320
    ds_read_b128 v[64:67], v6 offset:384
    ds_read_b128 v[68:71], v6 offset:448
    v_mov_b32 v104, 0x3f803f80
    v_mov_b32 v105, 0x3f803f80
    v_mov_b32 v106, 0x3f803f80
    v_mov_b32 v107, 0x3f803f80
    s_mov_b32 s46, 0x00ff00ff
    s_mov_b32 s47, 0x00ff00ff
    s_waitcnt lgkmcnt(0)
    v_mul_f32 v72, v8, v56
    v_mul_f32 v73, v9, v57
    v_mul_f32 v74, v10, v58
    v_mul_f32 v75, v11, v59
    v_mul_f32 v76, v12, v60
    v_mul_f32 v77, v13, v61
    v_mul_f32 v78, v14, v62
    v_mul_f32 v79, v15, v63
    v_min_f32 v72, 0, v72
    v_min_f32 v73, 0, v73
    v_min_f32 v74, 0, v74
    v_min_f32 v75, 0, v75
    v_min_f32 v76, 0, v76
    v_min_f32 v77, 0, v77
    v_min_f32 v78, 0, v78
    v_min_f32 v79, 0, v79
    v_exp_f32 v72, v72
    v_exp_f32 v73, v73
    v_exp_f32 v74, v74
    v_exp_f32 v75, v75
    v_exp_f32 v76, v76
    v_exp_f32 v77, v77
    v_exp_f32 v78, v78
    v_exp_f32 v79, v79
    v_max_f32 v128, 0, v8
    v_max_f32 v129, 0, v9
    v_max_f32 v130, 0, v10
    v_max_f32 v131, 0, v11
    v_max_f32 v132, 0, v12
    v_max_f32 v133, 0, v13
    v_max_f32 v134, 0, v14
    v_max_f32 v135, 0, v15
    v_add_f32 v72, 0x358637bd, v72
    v_add_f32 v73, 0x358637bd, v73
    v_add_f32 v74, 0x358637bd, v74
    v_add_f32 v75, 0x358637bd, v75
    v_add_f32 v76, 0x358637bd, v76
    v_add_f32 v77, 0x358637bd, v77
    v_add_f32 v78, 0x358637bd, v78
    v_add_f32 v79, 0x358637bd, v79
    v_fma_f32 v128, v128, v40, v72
    v_fma_f32 v129, v129, v41, v73
    v_fma_f32 v130, v130, v42, v74
    v_fma_f32 v131, v131, v43, v75
    v_fma_f32 v132, v132, v44, v76
    v_fma_f32 v133, v133, v45, v77
    v_fma_f32 v134, v134, v46, v78
    v_fma_f32 v135, v135, v47, v79
    v_mul_f32 v8, v8, v40
    v_cndmask_b32 v8, v8, v128, s[46:47]
    v_mul_f32 v9, v9, v41
    v_cndmask_b32 v9, v9, v129, s[46:47]
    v_mul_f32 v10, v10, v42
    v_cndmask_b32 v10, v10, v130, s[46:47]
    v_mul_f32 v11, v11, v43
    v_cndmask_b32 v11, v11, v131, s[46:47]
    v_cvt_pk_bf16_f32 v88, v8, v9
    v_cvt_pk_bf16_f32 v89, v10, v11
    v_mul_f32 v12, v12, v44
    v_cndmask_b32 v12, v12, v132, s[46:47]
    v_mul_f32 v13, v13, v45
    v_cndmask_b32 v13, v13, v133, s[46:47]
    v_mul_f32 v14, v14, v46
    v_cndmask_b32 v14, v14, v134, s[46:47]
    v_mul_f32 v15, v15, v47
    v_cndmask_b32 v15, v15, v135, s[46:47]
    v_cvt_pk_bf16_f32 v90, v12, v13
    v_cvt_pk_bf16_f32 v91, v14, v15
    ds_write_b128 v1, v[88:91] offset:1024
    v_mul_f32 v72, v16, v64
    v_mul_f32 v73, v17, v65
    v_mul_f32 v74, v18, v66
    v_mul_f32 v75, v19, v67
    v_mul_f32 v76, v20, v68
    v_mul_f32 v77, v21, v69
    v_mul_f32 v78, v22, v70
    v_mul_f32 v79, v23, v71
    v_min_f32 v72, 0, v72
    v_min_f32 v73, 0, v73
    v_min_f32 v74, 0, v74
    v_min_f32 v75, 0, v75
    v_min_f32 v76, 0, v76
    v_min_f32 v77, 0, v77
    v_min_f32 v78, 0, v78
    v_min_f32 v79, 0, v79
    v_exp_f32 v72, v72
    v_exp_f32 v73, v73
    v_exp_f32 v74, v74
    v_exp_f32 v75, v75
    v_exp_f32 v76, v76
    v_exp_f32 v77, v77
    v_exp_f32 v78, v78
    v_exp_f32 v79, v79
    v_max_f32 v128, 0, v16
    v_max_f32 v129, 0, v17
    v_max_f32 v130, 0, v18
    v_max_f32 v131, 0, v19
    v_max_f32 v132, 0, v20
    v_max_f32 v133, 0, v21
    v_max_f32 v134, 0, v22
    v_max_f32 v135, 0, v23
    v_add_f32 v72, 0x358637bd, v72
    v_add_f32 v73, 0x358637bd, v73
    v_add_f32 v74, 0x358637bd, v74
    v_add_f32 v75, 0x358637bd, v75
    v_add_f32 v76, 0x358637bd, v76
    v_add_f32 v77, 0x358637bd, v77
    v_add_f32 v78, 0x358637bd, v78
    v_add_f32 v79, 0x358637bd, v79
    v_fma_f32 v128, v128, v48, v72
    v_fma_f32 v129, v129, v49, v73
    v_fma_f32 v130, v130, v50, v74
    v_fma_f32 v131, v131, v51, v75
    v_fma_f32 v132, v132, v52, v76
    v_fma_f32 v133, v133, v53, v77
    v_fma_f32 v134, v134, v54, v78
    v_fma_f32 v135, v135, v55, v79
    v_mul_f32 v16, v16, v48
    v_cndmask_b32 v16, v16, v128, s[46:47]
    v_mul_f32 v17, v17, v49
    v_cndmask_b32 v17, v17, v129, s[46:47]
    v_mul_f32 v18, v18, v50
    v_cndmask_b32 v18, v18, v130, s[46:47]
    v_mul_f32 v19, v19, v51
    v_cndmask_b32 v19, v19, v131, s[46:47]
    v_cvt_pk_bf16_f32 v92, v16, v17
    v_cvt_pk_bf16_f32 v93, v18, v19
    v_mul_f32 v20, v20, v52
    v_cndmask_b32 v20, v20, v132, s[46:47]
    v_mul_f32 v21, v21, v53
    v_cndmask_b32 v21, v21, v133, s[46:47]
    v_mul_f32 v22, v22, v54
    v_cndmask_b32 v22, v22, v134, s[46:47]
    v_mul_f32 v23, v23, v55
    v_cndmask_b32 v23, v23, v135, s[46:47]
    v_cvt_pk_bf16_f32 v94, v20, v21
    v_cvt_pk_bf16_f32 v95, v22, v23
    ds_write_b128 v1, v[92:95] offset:2048
    v_mov_b32 v6, 3
    ds_write_b32 v167, v6 offset:512
    s_setprio 0
    v_and_b32 v4, 0x380, v1
    v_and_b32 v5, 4, v2
    v_lshl_add_u32 v4, v5, 2, v4
    v_and_b32 v5, 3, v2
    v_lshl_add_u32 v4, v5, 5, v4
    ds_read_b128 v[96:99], v4 offset:1024
    ds_read_b128 v[100:103], v4 offset:2048
    s_waitcnt lgkmcnt(0)
    v_mfma_f32_16x16x32_bf16 v[112:115], v[96:99], v[88:91], 0
    v_mfma_f32_16x16x32_bf16 v[116:119], v[104:107], v[88:91], 0
    v_mfma_f32_16x16x32_bf16 v[112:115], v[100:103], v[92:95], v[112:115]
    v_mfma_f32_16x16x32_bf16 v[116:119], v[104:107], v[92:95], v[116:119]
    v_lshlrev_b32 v6, 2, v2
    ds_read_b32 v40, v6 offset:0
    ds_read_b32 v41, v6 offset:64
    ds_read_b32 v42, v6 offset:128
    ds_read_b32 v43, v6 offset:192
    ds_read_b32 v44, v6 offset:256
    ds_read_b32 v45, v6 offset:320
    ds_read_b32 v46, v6 offset:384
    ds_read_b32 v47, v6 offset:448
    v_bfe_u32 v4, v2, 1, 2
    v_mul_u32_u24 v4, 1536, v4
    v_and_b32 v5, 1, v2
    v_lshl_add_u32 v4, v5, 2, v4
    v_add_u32 v5, 2, v3
    v_and_b32 v5, 3, v5
    v_lshl_add_u32 v4, v5, 3, v4
    s_mul_i32 s6, s13, 6144
    s_add_u32 s6, s6, s96
    s_mov_b32 s40, 0xc0c0c0c
    s_mov_b32 s41, 0xc0c0c0c
    s_mov_b32 s42, 0x30303030
    s_mov_b32 s43, 0x30303030
    s_mov_b32 s44, 0xc0c0c0c0
    s_mov_b32 s45, 0xc0c0c0c0
    v_cndmask_b32 v120, v112, v113, s[40:41]
    v_cndmask_b32 v120, v120, v114, s[42:43]
    v_cndmask_b32 v120, v120, v115, s[44:45]
    s_mov_b32 s40, 0xffff
    s_mov_b32 s41, 0
    v_cndmask_b32 v120, v120, v116, s[40:41]
    s_mov_b32 exec_lo, 0xff
    s_mov_b32 exec_hi, 0x00ff00ff
    buffer_atomic_add_f32 v120, v4, s[8:11], s6 offen offset:1408
    s_mov_b64 exec, -1
    s_lshl_b32 s6, s14, 4
    s_add_u32 s6, s6, s13
    s_mul_i32 s6, s6, 4608
    s_add_u32 s6, s6, s87
    s_add_u32 s6, s6, 22781952
    s_add_u32 s6, s6, 4096
    s_add_u32 s7, s6, 36864
    v_lshlrev_b32 v5, 3, v0
    s_waitcnt lgkmcnt(0)
    s_mov_b32 s40, 0xffff0000
    s_mov_b32 s41, 0xffff0000
    v_cndmask_b32 v24, v24, v26, s[40:41]
    v_cndmask_b32 v25, v25, v27, s[40:41]
    v_cndmask_b32 v28, v28, v30, s[40:41]
    v_cndmask_b32 v29, v29, v31, s[40:41]
    v_cndmask_b32 v32, v32, v34, s[40:41]
    v_cndmask_b32 v33, v33, v35, s[40:41]
    v_cndmask_b32 v36, v36, v38, s[40:41]
    v_cndmask_b32 v37, v37, v39, s[40:41]
    v_mul_f32 v72, v24, v44
    v_mul_f32 v73, v25, v44
    v_mul_f32 v74, v28, v45
    v_mul_f32 v75, v29, v45
    v_mul_f32 v76, v32, v46
    v_mul_f32 v77, v33, v46
    v_mul_f32 v78, v36, v47
    v_mul_f32 v79, v37, v47
    v_min_f32 v72, 0, v72
    v_min_f32 v73, 0, v73
    v_min_f32 v74, 0, v74
    v_min_f32 v75, 0, v75
    v_min_f32 v76, 0, v76
    v_min_f32 v77, 0, v77
    v_min_f32 v78, 0, v78
    v_min_f32 v79, 0, v79
    v_exp_f32 v72, v72
    v_exp_f32 v73, v73
    v_exp_f32 v74, v74
    v_exp_f32 v75, v75
    v_exp_f32 v76, v76
    v_exp_f32 v77, v77
    v_exp_f32 v78, v78
    v_exp_f32 v79, v79
    v_max_f32 v24, 0, v24
    v_max_f32 v25, 0, v25
    v_max_f32 v28, 0, v28
    v_max_f32 v29, 0, v29
    v_max_f32 v32, 0, v32
    v_max_f32 v33, 0, v33
    v_max_f32 v36, 0, v36
    v_max_f32 v37, 0, v37
    v_add_f32 v72, 0x358637bd, v72
    v_add_f32 v73, 0x358637bd, v73
    v_add_f32 v74, 0x358637bd, v74
    v_add_f32 v75, 0x358637bd, v75
    v_add_f32 v76, 0x358637bd, v76
    v_add_f32 v77, 0x358637bd, v77
    v_add_f32 v78, 0x358637bd, v78
    v_add_f32 v79, 0x358637bd, v79
    v_fma_f32 v24, v24, v40, v72
    v_fma_f32 v25, v25, v40, v73
    v_fma_f32 v28, v28, v41, v74
    v_fma_f32 v29, v29, v41, v75
    v_fma_f32 v32, v32, v42, v76
    v_fma_f32 v33, v33, v42, v77
    v_fma_f32 v36, v36, v43, v78
    v_fma_f32 v37, v37, v43, v79
    v_cvt_pk_bf16_f32 v128, v24, v25
    v_cvt_pk_bf16_f32 v129, v28, v29
    v_cvt_pk_bf16_f32 v130, v32, v33
    v_cvt_pk_bf16_f32 v131, v36, v37
    buffer_store_dwordx2 v[128:129], v5, s[8:11], s6 offen sc1
    buffer_store_dwordx2 v[130:131], v5, s[8:11], s7 offen sc1
    s_branch s1_done
s1_stats:
    s_setprio 3
    v_mov_b32 v40, 0x3f803f80
    v_mov_b32 v41, 0x3f803f80
    v_mov_b32 v42, 0x3f803f80
    v_mov_b32 v43, 0x3f803f80
    s_mov_b32 s40, 0x22222222
    s_mov_b32 s41, 0x22222222
    s_mov_b32 s42, 0x44444444
    s_mov_b32 s43, 0x44444444
    s_mov_b32 s44, 0x88888888
    s_mov_b32 s45, 0x88888888
    s_waitcnt lgkmcnt(0)
    v_mfma_f32_16x16x32_bf16 v[24:27], v[112:115], v[112:115], 0
    ds_read_b128 v[128:131], v145 offset:0
    ds_read_b128 v[132:135], v145 offset:2048
    v_mfma_f32_16x16x32_bf16 v[28:31], v[116:119], v[116:119], 0
    ds_read_b128 v[136:139], v145 offset:4096
    ds_read_b128 v[140:143], v145 offset:6144
    v_mfma_f32_16x16x32_bf16 v[32:35], v[120:123], v[120:123], 0
    v_mfma_f32_16x16x32_bf16 v[36:39], v[124:127], v[124:127], 0
    v_mfma_f32_16x16x32_bf16 v[8:11], v[40:43], v[112:115], 0
    v_mfma_f32_16x16x32_bf16 v[12:15], v[40:43], v[116:119], 0
    v_mfma_f32_16x16x32_bf16 v[16:19], v[40:43], v[120:123], 0
    s_waitcnt lgkmcnt(0)
    v_mfma_f32_16x16x32_bf16 v[20:23], v[40:43], v[124:127], 0
    v_mfma_f32_16x16x32_bf16 v[24:27], v[128:131], v[128:131], v[24:27]
    ds_read_b128 v[112:115], v144 offset:8192
    ds_read_b128 v[116:119], v144 offset:10240
    v_mfma_f32_16x16x32_bf16 v[28:31], v[132:135], v[132:135], v[28:31]
    ds_read_b128 v[120:123], v144 offset:12288
    ds_read_b128 v[124:127], v144 offset:14336
    v_mfma_f32_16x16x32_bf16 v[32:35], v[136:139], v[136:139], v[32:35]
    v_mfma_f32_16x16x32_bf16 v[36:39], v[140:143], v[140:143], v[36:39]
    v_mfma_f32_16x16x32_bf16 v[8:11], v[40:43], v[128:131], v[8:11]
    v_mfma_f32_16x16x32_bf16 v[12:15], v[40:43], v[132:135], v[12:15]
    v_mfma_f32_16x16x32_bf16 v[16:19], v[40:43], v[136:139], v[16:19]
    s_waitcnt lgkmcnt(0)
    v_mfma_f32_16x16x32_bf16 v[20:23], v[40:43], v[140:143], v[20:23]
    v_mfma_f32_16x16x32_bf16 v[24:27], v[112:115], v[112:115], v[24:27]
    ds_read_b128 v[128:131], v145 offset:8192
    ds_read_b128 v[132:135], v145 offset:10240
    v_mfma_f32_16x16x32_bf16 v[28:31], v[116:119], v[116:119], v[28:31]
    ds_read_b128 v[136:139], v145 offset:12288
    ds_read_b128 v[140:143], v145 offset:14336
    v_mfma_f32_16x16x32_bf16 v[32:35], v[120:123], v[120:123], v[32:35]
    v_mfma_f32_16x16x32_bf16 v[36:39], v[124:127], v[124:127], v[36:39]
    v_mfma_f32_16x16x32_bf16 v[8:11], v[40:43], v[112:115], v[8:11]
    v_mfma_f32_16x16x32_bf16 v[12:15], v[40:43], v[116:119], v[12:15]
    v_mfma_f32_16x16x32_bf16 v[16:19], v[40:43], v[120:123], v[16:19]
    s_waitcnt lgkmcnt(0)
    v_mfma_f32_16x16x32_bf16 v[20:23], v[40:43], v[124:127], v[20:23]
    v_mfma_f32_16x16x32_bf16 v[24:27], v[128:131], v[128:131], v[24:27]
    ds_read_b128 v[112:115], v144 offset:16384
    ds_read_b128 v[116:119], v144 offset:18432
    v_mfma_f32_16x16x32_bf16 v[28:31], v[132:135], v[132:135], v[28:31]
    ds_read_b128 v[120:123], v144 offset:20480
    ds_read_b128 v[124:127], v144 offset:22528
    v_mfma_f32_16x16x32_bf16 v[32:35], v[136:139], v[136:139], v[32:35]
    v_mfma_f32_16x16x32_bf16 v[36:39], v[140:143], v[140:143], v[36:39]
    v_mfma_f32_16x16x32_bf16 v[8:11], v[40:43], v[128:131], v[8:11]
    v_mfma_f32_16x16x32_bf16 v[12:15], v[40:43], v[132:135], v[12:15]
    v_mfma_f32_16x16x32_bf16 v[16:19], v[40:43], v[136:139], v[16:19]
    s_waitcnt lgkmcnt(0)
    v_mfma_f32_16x16x32_bf16 v[20:23], v[40:43], v[140:143], v[20:23]
    v_mfma_f32_16x16x32_bf16 v[24:27], v[112:115], v[112:115], v[24:27]
    ds_read_b128 v[128:131], v145 offset:16384
    ds_read_b128 v[132:135], v145 offset:18432
    v_mfma_f32_16x16x32_bf16 v[28:31], v[116:119], v[116:119], v[28:31]
    ds_read_b128 v[136:139], v145 offset:20480
    ds_read_b128 v[140:143], v145 offset:22528
    v_mfma_f32_16x16x32_bf16 v[32:35], v[120:123], v[120:123], v[32:35]
    ds_read_b32 v6, v167 offset:520
    v_mfma_f32_16x16x32_bf16 v[36:39], v[124:127], v[124:127], v[36:39]
    v_mfma_f32_16x16x32_bf16 v[8:11], v[40:43], v[112:115], v[8:11]
    v_mfma_f32_16x16x32_bf16 v[12:15], v[40:43], v[116:119], v[12:15]
    v_mfma_f32_16x16x32_bf16 v[16:19], v[40:43], v[120:123], v[16:19]
    s_waitcnt lgkmcnt(0)
    v_readfirstlane_b32 s4, v6
    v_mfma_f32_16x16x32_bf16 v[20:23], v[40:43], v[124:127], v[20:23]
    s_andn2_b32 s4, 0x400, s4
    s_cbranch_scc1 s1_slowS4
s1_backS4:
    v_mfma_f32_16x16x32_bf16 v[24:27], v[128:131], v[128:131], v[24:27]
    ds_read_b128 v[112:115], v146 offset:0
    ds_read_b128 v[116:119], v146 offset:2048
    v_mfma_f32_16x16x32_bf16 v[28:31], v[132:135], v[132:135], v[28:31]
    ds_read_b128 v[120:123], v146 offset:4096
    ds_read_b128 v[124:127], v146 offset:6144
    v_mfma_f32_16x16x32_bf16 v[32:35], v[136:139], v[136:139], v[32:35]
    v_mfma_f32_16x16x32_bf16 v[36:39], v[140:143], v[140:143], v[36:39]
    v_mfma_f32_16x16x32_bf16 v[8:11], v[40:43], v[128:131], v[8:11]
    v_mfma_f32_16x16x32_bf16 v[12:15], v[40:43], v[132:135], v[12:15]
    v_mfma_f32_16x16x32_bf16 v[16:19], v[40:43], v[136:139], v[16:19]
    s_waitcnt lgkmcnt(0)
    v_mfma_f32_16x16x32_bf16 v[20:23], v[40:43], v[140:143], v[20:23]
    v_mfma_f32_16x16x32_bf16 v[24:27], v[112:115], v[112:115], v[24:27]
    ds_read_b128 v[128:131], v147 offset:0
    ds_read_b128 v[132:135], v147 offset:2048
    v_mfma_f32_16x16x32_bf16 v[28:31], v[116:119], v[116:119], v[28:31]
    ds_read_b128 v[136:139], v147 offset:4096
    ds_read_b128 v[140:143], v147 offset:6144
    v_mfma_f32_16x16x32_bf16 v[32:35], v[120:123], v[120:123], v[32:35]
    v_mfma_f32_16x16x32_bf16 v[36:39], v[124:127], v[124:127], v[36:39]
    v_mfma_f32_16x16x32_bf16 v[8:11], v[40:43], v[112:115], v[8:11]
    v_mfma_f32_16x16x32_bf16 v[12:15], v[40:43], v[116:119], v[12:15]
    v_mfma_f32_16x16x32_bf16 v[16:19], v[40:43], v[120:123], v[16:19]
    s_waitcnt lgkmcnt(0)
    v_mfma_f32_16x16x32_bf16 v[20:23], v[40:43], v[124:127], v[20:23]
    v_mfma_f32_16x16x32_bf16 v[24:27], v[128:131], v[128:131], v[24:27]
    ds_read_b128 v[112:115], v146 offset:8192
    ds_read_b128 v[116:119], v146 offset:10240
    v_mfma_f32_16x16x32_bf16 v[28:31], v[132:135], v[132:135], v[28:31]
    ds_read_b128 v[120:123], v146 offset:12288
    ds_read_b128 v[124:127], v146 offset:14336
    v_mfma_f32_16x16x32_bf16 v[32:35], v[136:139], v[136:139], v[32:35]
    v_mfma_f32_16x16x32_bf16 v[36:39], v[140:143], v[140:143], v[36:39]
    v_mfma_f32_16x16x32_bf16 v[8:11], v[40:43], v[128:131], v[8:11]
    v_mfma_f32_16x16x32_bf16 v[12:15], v[40:43], v[132:135], v[12:15]
    v_mfma_f32_16x16x32_bf16 v[16:19], v[40:43], v[136:139], v[16:19]
    s_waitcnt lgkmcnt(0)
    v_mfma_f32_16x16x32_bf16 v[20:23], v[40:43], v[140:143], v[20:23]
    v_mfma_f32_16x16x32_bf16 v[24:27], v[112:115], v[112:115], v[24:27]
    ds_read_b128 v[128:131], v147 offset:8192
    ds_read_b128 v[132:135], v147 offset:10240
    v_mfma_f32_16x16x32_bf16 v[28:31], v[116:119], v[116:119], v[28:31]
    ds_read_b128 v[136:139], v147 offset:12288
    ds_read_b128 v[140:143], v147 offset:14336
    v_mfma_f32_16x16x32_bf16 v[32:35], v[120:123], v[120:123], v[32:35]
    v_mfma_f32_16x16x32_bf16 v[36:39], v[124:127], v[124:127], v[36:39]
    v_mfma_f32_16x16x32_bf16 v[8:11], v[40:43], v[112:115], v[8:11]
    v_mfma_f32_16x16x32_bf16 v[12:15], v[40:43], v[116:119], v[12:15]
    v_mfma_f32_16x16x32_bf16 v[16:19], v[40:43], v[120:123], v[16:19]
    s_waitcnt lgkmcnt(0)
    v_mfma_f32_16x16x32_bf16 v[20:23], v[40:43], v[124:127], v[20:23]
    v_mfma_f32_16x16x32_bf16 v[24:27], v[128:131], v[128:131], v[24:27]
    ds_read_b128 v[112:115], v146 offset:16384
    ds_read_b128 v[116:119], v146 offset:18432
    v_mfma_f32_16x16x32_bf16 v[28:31], v[132:135], v[132:135], v[28:31]
    ds_read_b128 v[120:123], v146 offset:20480
    ds_read_b128 v[124:127], v146 offset:22528
    v_mfma_f32_16x16x32_bf16 v[32:35], v[136:139], v[136:139], v[32:35]
    v_mfma_f32_16x16x32_bf16 v[36:39], v[140:143], v[140:143], v[36:39]
    v_mfma_f32_16x16x32_bf16 v[8:11], v[40:43], v[128:131], v[8:11]
    v_mfma_f32_16x16x32_bf16 v[12:15], v[40:43], v[132:135], v[12:15]
    v_mfma_f32_16x16x32_bf16 v[16:19], v[40:43], v[136:139], v[16:19]
    s_waitcnt lgkmcnt(0)
    v_mfma_f32_16x16x32_bf16 v[20:23], v[40:43], v[140:143], v[20:23]
    v_mfma_f32_16x16x32_bf16 v[24:27], v[112:115], v[112:115], v[24:27]
    ds_read_b128 v[128:131], v147 offset:16384
    ds_read_b128 v[132:135], v147 offset:18432
    v_mfma_f32_16x16x32_bf16 v[28:31], v[116:119], v[116:119], v[28:31]
    ds_read_b128 v[136:139], v147 offset:20480
    ds_read_b128 v[140:143], v147 offset:22528
    v_mfma_f32_16x16x32_bf16 v[32:35], v[120:123], v[120:123], v[32:35]
    ds_read_b32 v6, v167 offset:520
    v_mfma_f32_16x16x32_bf16 v[36:39], v[124:127], v[124:127], v[36:39]
    v_mfma_f32_16x16x32_bf16 v[8:11], v[40:43], v[112:115], v[8:11]
    v_mfma_f32_16x16x32_bf16 v[12:15], v[40:43], v[116:119], v[12:15]
    v_mfma_f32_16x16x32_bf16 v[16:19], v[40:43], v[120:123], v[16:19]
    s_waitcnt lgkmcnt(0)
    v_readfirstlane_b32 s4, v6
    v_mfma_f32_16x16x32_bf16 v[20:23], v[40:43], v[124:127], v[20:23]
    s_andn2_b32 s4, 0x40000, s4
    s_cbranch_scc1 s1_slowS10
s1_backS10:
    v_mfma_f32_16x16x32_bf16 v[24:27], v[128:131], v[128:131], v[24:27]
    ds_read_b128 v[112:115], v148 offset:0
    ds_read_b128 v[116:119], v148 offset:2048
    v_mfma_f32_16x16x32_bf16 v[28:31], v[132:135], v[132:135], v[28:31]
    ds_read_b128 v[120:123], v148 offset:4096
    ds_read_b128 v[124:127], v148 offset:6144
    v_mfma_f32_16x16x32_bf16 v[32:35], v[136:139], v[136:139], v[32:35]
    v_mfma_f32_16x16x32_bf16 v[36:39], v[140:143], v[140:143], v[36:39]
    v_mfma_f32_16x16x32_bf16 v[8:11], v[40:43], v[128:131], v[8:11]
    v_mfma_f32_16x16x32_bf16 v[12:15], v[40:43], v[132:135], v[12:15]
    v_mfma_f32_16x16x32_bf16 v[16:19], v[40:43], v[136:139], v[16:19]
    s_waitcnt lgkmcnt(0)
    v_mfma_f32_16x16x32_bf16 v[20:23], v[40:43], v[140:143], v[20:23]
    v_mfma_f32_16x16x32_bf16 v[24:27], v[112:115], v[112:115], v[24:27]
    ds_read_b128 v[128:131], v149 offset:0
    ds_read_b128 v[132:135], v149 offset:2048
    v_mfma_f32_16x16x32_bf16 v[28:31], v[116:119], v[116:119], v[28:31]
    ds_read_b128 v[136:139], v149 offset:4096
    ds_read_b128 v[140:143], v149 offset:6144
    v_mfma_f32_16x16x32_bf16 v[32:35], v[120:123], v[120:123], v[32:35]
    v_mfma_f32_16x16x32_bf16 v[36:39], v[124:127], v[124:127], v[36:39]
    v_mfma_f32_16x16x32_bf16 v[8:11], v[40:43], v[112:115], v[8:11]
    v_mfma_f32_16x16x32_bf16 v[12:15], v[40:43], v[116:119], v[12:15]
    v_mfma_f32_16x16x32_bf16 v[16:19], v[40:43], v[120:123], v[16:19]
    s_waitcnt lgkmcnt(0)
    v_mfma_f32_16x16x32_bf16 v[20:23], v[40:43], v[124:127], v[20:23]
    v_mfma_f32_16x16x32_bf16 v[24:27], v[128:131], v[128:131], v[24:27]
    ds_read_b128 v[112:115], v148 offset:8192
    ds_read_b128 v[116:119], v148 offset:10240
    v_mfma_f32_16x16x32_bf16 v[28:31], v[132:135], v[132:135], v[28:31]
    ds_read_b128 v[120:123], v148 offset:12288
    ds_read_b128 v[124:127], v148 offset:14336
    v_mfma_f32_16x16x32_bf16 v[32:35], v[136:139], v[136:139], v[32:35]
    v_mfma_f32_16x16x32_bf16 v[36:39], v[140:143], v[140:143], v[36:39]
    v_mfma_f32_16x16x32_bf16 v[8:11], v[40:43], v[128:131], v[8:11]
    v_mfma_f32_16x16x32_bf16 v[12:15], v[40:43], v[132:135], v[12:15]
    v_mfma_f32_16x16x32_bf16 v[16:19], v[40:43], v[136:139], v[16:19]
    s_waitcnt lgkmcnt(0)
    v_mfma_f32_16x16x32_bf16 v[20:23], v[40:43], v[140:143], v[20:23]
    v_mfma_f32_16x16x32_bf16 v[24:27], v[112:115], v[112:115], v[24:27]
    ds_read_b128 v[128:131], v149 offset:8192
    ds_read_b128 v[132:135], v149 offset:10240
    v_mfma_f32_16x16x32_bf16 v[28:31], v[116:119], v[116:119], v[28:31]
    ds_read_b128 v[136:139], v149 offset:12288
    ds_read_b128 v[140:143], v149 offset:14336
    v_mfma_f32_16x16x32_bf16 v[32:35], v[120:123], v[120:123], v[32:35]
    v_mfma_f32_16x16x32_bf16 v[36:39], v[124:127], v[124:127], v[36:39]
    v_mfma_f32_16x16x32_bf16 v[8:11], v[40:43], v[112:115], v[8:11]
    v_mfma_f32_16x16x32_bf16 v[12:15], v[40:43], v[116:119], v[12:15]
    v_mfma_f32_16x16x32_bf16 v[16:19], v[40:43], v[120:123], v[16:19]
    s_waitcnt lgkmcnt(0)
    v_mfma_f32_16x16x32_bf16 v[20:23], v[40:43], v[124:127], v[20:23]
    v_mfma_f32_16x16x32_bf16 v[24:27], v[128:131], v[128:131], v[24:27]
    ds_read_b128 v[112:115], v148 offset:16384
    ds_read_b128 v[116:119], v148 offset:18432
    v_mfma_f32_16x16x32_bf16 v[28:31], v[132:135], v[132:135], v[28:31]
    ds_read_b128 v[120:123], v148 offset:20480
    ds_read_b128 v[124:127], v148 offset:22528
    v_mfma_f32_16x16x32_bf16 v[32:35], v[136:139], v[136:139], v[32:35]
    v_mfma_f32_16x16x32_bf16 v[36:39], v[140:143], v[140:143], v[36:39]
    v_mfma_f32_16x16x32_bf16 v[8:11], v[40:43], v[128:131], v[8:11]
    v_mfma_f32_16x16x32_bf16 v[12:15], v[40:43], v[132:135], v[12:15]
    v_mfma_f32_16x16x32_bf16 v[16:19], v[40:43], v[136:139], v[16:19]
    s_waitcnt lgkmcnt(0)
    v_mfma_f32_16x16x32_bf16 v[20:23], v[40:43], v[140:143], v[20:23]
    v_mfma_f32_16x16x32_bf16 v[24:27], v[112:115], v[112:115], v[24:27]
    ds_read_b128 v[128:131], v149 offset:16384
    ds_read_b128 v[132:135], v149 offset:18432
    v_mfma_f32_16x16x32_bf16 v[28:31], v[116:119], v[116:119], v[28:31]
    ds_read_b128 v[136:139], v149 offset:20480
    ds_read_b128 v[140:143], v149 offset:22528
    v_mfma_f32_16x16x32_bf16 v[32:35], v[120:123], v[120:123], v[32:35]
    v_mfma_f32_16x16x32_bf16 v[36:39], v[124:127], v[124:127], v[36:39]
    v_mfma_f32_16x16x32_bf16 v[8:11], v[40:43], v[112:115], v[8:11]
    v_mfma_f32_16x16x32_bf16 v[12:15], v[40:43], v[116:119], v[12:15]
    v_mfma_f32_16x16x32_bf16 v[16:19], v[40:43], v[120:123], v[16:19]
    s_waitcnt lgkmcnt(0)
    v_mfma_f32_16x16x32_bf16 v[20:23], v[40:43], v[124:127], v[20:23]
    v_mfma_f32_16x16x32_bf16 v[24:27], v[128:131], v[128:131], v[24:27]
    v_mfma_f32_16x16x32_bf16 v[28:31], v[132:135], v[132:135], v[28:31]
    v_mfma_f32_16x16x32_bf16 v[32:35], v[136:139], v[136:139], v[32:35]
    v_mfma_f32_16x16x32_bf16 v[36:39], v[140:143], v[140:143], v[36:39]
    v_mfma_f32_16x16x32_bf16 v[8:11], v[40:43], v[128:131], v[8:11]
    v_mfma_f32_16x16x32_bf16 v[12:15], v[40:43], v[132:135], v[12:15]
    v_mfma_f32_16x16x32_bf16 v[16:19], v[40:43], v[136:139], v[16:19]
    v_mfma_f32_16x16x32_bf16 v[20:23], v[40:43], v[140:143], v[20:23]
    v_lshlrev_b32 v6, 2, v2
    v_cndmask_b32 v24, v24, v25, s[40:41]
    v_cndmask_b32 v28, v28, v29, s[40:41]
    v_cndmask_b32 v32, v32, v33, s[40:41]
    v_cndmask_b32 v36, v36, v37, s[40:41]
    v_cndmask_b32 v24, v24, v26, s[42:43]
    v_cndmask_b32 v28, v28, v30, s[42:43]
    v_cndmask_b32 v32, v32, v34, s[42:43]
    v_cndmask_b32 v36, v36, v38, s[42:43]
    v_cndmask_b32 v24, v24, v27, s[44:45]
    v_cndmask_b32 v28, v28, v31, s[44:45]
    v_cndmask_b32 v32, v32, v35, s[44:45]
    v_cndmask_b32 v36, v36, v39, s[44:45]
    v_mul_f32 v24, 0x3ae38e39, v24
    v_mul_f32 v28, 0x3ae38e39, v28
    v_mul_f32 v32, 0x3ae38e39, v32
    v_mul_f32 v36, 0x3ae38e39, v36
    v_mul_f32 v8, 0x3ae38e39, v8
    v_mul_f32 v12, 0x3ae38e39, v12
    v_mul_f32 v16, 0x3ae38e39, v16
    v_mul_f32 v20, 0x3ae38e39, v20
    v_fma_f32 v24, -v8, v8, v24
    v_fma_f32 v28, -v12, v12, v28
    v_fma_f32 v32, -v16, v16, v32
    v_fma_f32 v36, -v20, v20, v36
    v_max_f32 v24, 0, v24
    v_max_f32 v28, 0, v28
    v_max_f32 v32, 0, v32
    v_max_f32 v36, 0, v36
    v_add_f32 v24, 0x3727c5ac, v24
    v_add_f32 v28, 0x3727c5ac, v28
    v_add_f32 v32, 0x3727c5ac, v32
    v_add_f32 v36, 0x3727c5ac, v36
    v_rsq_f32 v10, v24
    v_rsq_f32 v14, v28
    v_rsq_f32 v18, v32
    v_rsq_f32 v22, v36
    v_mul_f32 v11, 0x3fb8aa3b, v10
    v_mul_f32 v15, 0x3fb8aa3b, v14
    v_mul_f32 v19, 0x3fb8aa3b, v18
    v_mul_f32 v23, 0x3fb8aa3b, v22
    s_mov_b32 exec_lo, 0x00f0000f
    s_mov_b32 exec_hi, 0xf0000f00
    ds_write_b32 v6, v10 offset:0
    ds_write_b32 v6, v11 offset:256
    ds_write_b32 v6, v14 offset:64
    ds_write_b32 v6, v15 offset:320
    ds_write_b32 v6, v18 offset:128
    ds_write_b32 v6, v19 offset:384
    ds_write_b32 v6, v22 offset:192
    ds_write_b32 v6, v23 offset:448
    s_mov_b64 exec, -1
    v_mov_b32 v4, 2
    ds_write_b32 v167, v4 offset:512
    s_setprio 0
    s_branch s1_done
s1_slowTT4:
    s_mov_b32 s5, 0
s1_slTT4:
    ds_read_b32 v6, v167 offset:520
    s_waitcnt lgkmcnt(0)
    v_readfirstlane_b32 s4, v6
    s_nop 0
    s_and_b32 s4, s4, 0x400
    s_cmp_eq_u32 s4, 0x400
    s_cbranch_scc1 s1_slTT4_ok
    s_sleep 1
    s_add_u32 s5, s5, 1
    s_cmp_lt_u32 s5, 0x40000
    s_cbranch_scc1 s1_slTT4
    s_endpgm
s1_slTT4_ok:
    s_branch s1_backTT4
s1_slowTT10:
    s_mov_b32 s5, 0
s1_slTT10:
    ds_read_b32 v6, v167 offset:520
    s_waitcnt lgkmcnt(0)
    v_readfirstlane_b32 s4, v6
    s_nop 0
    s_and_b32 s4, s4, 0x40000
    s_cmp_eq_u32 s4, 0x40000
    s_cbranch_scc1 s1_slTT10_ok
    s_sleep 1
    s_add_u32 s5, s5, 1
    s_cmp_lt_u32 s5, 0x40000
    s_cbranch_scc1 s1_slTT10
    s_endpgm
s1_slTT10_ok:
    s_branch s1_backTT10
s1_slowNN4:
    s_mov_b32 s5, 0
s1_slNN4:
    ds_read_b32 v6, v167 offset:520
    s_waitcnt lgkmcnt(0)
    v_readfirstlane_b32 s4, v6
    s_nop 0
    s_and_b32 s4, s4, 0x400
    s_cmp_eq_u32 s4, 0x400
    s_cbranch_scc1 s1_slNN4_ok
    s_sleep 1
    s_add_u32 s5, s5, 1
    s_cmp_lt_u32 s5, 0x40000
    s_cbranch_scc1 s1_slNN4
    s_endpgm
s1_slNN4_ok:
    s_branch s1_backNN4
s1_slowNN10:
    s_mov_b32 s5, 0
s1_slNN10:
    ds_read_b32 v6, v167 offset:520
    s_waitcnt lgkmcnt(0)
    v_readfirstlane_b32 s4, v6
    s_nop 0
    s_and_b32 s4, s4, 0x40000
    s_cmp_eq_u32 s4, 0x40000
    s_cbranch_scc1 s1_slNN10_ok
    s_sleep 1
    s_add_u32 s5, s5, 1
    s_cmp_lt_u32 s5, 0x40000
    s_cbranch_scc1 s1_slNN10
    s_endpgm
s1_slNN10_ok:
    s_branch s1_backNN10
s1_slowNT4:
    s_mov_b32 s5, 0
s1_slNT4:
    ds_read_b32 v6, v167 offset:520
    s_waitcnt lgkmcnt(0)
    v_readfirstlane_b32 s4, v6
    s_nop 0
    s_and_b32 s4, s4, 0x400
    s_cmp_eq_u32 s4, 0x400
    s_cbranch_scc1 s1_slNT4_ok
    s_sleep 1
    s_add_u32 s5, s5, 1
    s_cmp_lt_u32 s5, 0x40000
    s_cbranch_scc1 s1_slNT4
    s_endpgm
s1_slNT4_ok:
    s_branch s1_backNT4
s1_slowNT10:
    s_mov_b32 s5, 0
s1_slNT10:
    ds_read_b32 v6, v167 offset:520
    s_waitcnt lgkmcnt(0)
    v_readfirstlane_b32 s4, v6
    s_nop 0
    s_and_b32 s4, s4, 0x40000
    s_cmp_eq_u32 s4, 0x40000
    s_cbranch_scc1 s1_slNT10_ok
    s_sleep 1
    s_add_u32 s5, s5, 1
    s_cmp_lt_u32 s5, 0x40000
    s_cbranch_scc1 s1_slNT10
    s_endpgm
s1_slNT10_ok:
    s_branch s1_backNT10
s1_slowS4:
    s_mov_b32 s5, 0
s1_slS4:
    ds_read_b32 v6, v167 offset:520
    s_waitcnt lgkmcnt(0)
    v_readfirstlane_b32 s4, v6
    s_nop 0
    s_and_b32 s4, s4, 0x400
    s_cmp_eq_u32 s4, 0x400
    s_cbranch_scc1 s1_slS4_ok
    s_sleep 1
    s_add_u32 s5, s5, 1
    s_cmp_lt_u32 s5, 0x40000
    s_cbranch_scc1 s1_slS4
    s_endpgm
s1_slS4_ok:
    s_branch s1_backS4
s1_slowS10:
    s_mov_b32 s5, 0
s1_slS10:
    ds_read_b32 v6, v167 offset:520
    s_waitcnt lgkmcnt(0)
    v_readfirstlane_b32 s4, v6
    s_nop 0
    s_and_b32 s4, s4, 0x40000
    s_cmp_eq_u32 s4, 0x40000
    s_cbranch_scc1 s1_slS10_ok
    s_sleep 1
    s_add_u32 s5, s5, 1
    s_cmp_lt_u32 s5, 0x40000
    s_cbranch_scc1 s1_slS10
    s_endpgm
s1_slS10_ok:
    s_branch s1_backS10
s1_wo0:
    s_cmp_eq_u32 s35, 0
    s_cbranch_scc1 s1_wo
    v_bfe_u32 v6, v0, 2, 2
    v_lshl_add_u32 v5, v3, 3, v6
    v_lshlrev_b32 v5, 7, v5
    v_and_b32 v6, 8, v0
    v_lshl_add_u32 v5, v6, 3, v5
    v_add_u32 v4, s22, v5
    v_xor_b32 v5, 64, v4
    v_and_b32 v6, 3, v0
    s_lshl_b32 s4, s33, 1
    s_add_u32 s4, s4, 0
    s_mul_i32 s5, s4, 43691
    s_lshr_b32 s5, s5, 17
    s_mul_i32 s5, s5, 3
    s_sub_u32 s4, s4, s5
    s_cmp_eq_u32 s4, 1
    s_cselect_b32 s4, 3, 4
    s_cselect_b32 s5, 32, 8
    v_lshl_add_u32 v8, v6, s4, v4
    v_add_u32 v9, s5, v8
    s_lshl_b32 s4, s33, 1
    s_add_u32 s4, s4, 1
    s_mul_i32 s5, s4, 43691
    s_lshr_b32 s5, s5, 17
    s_mul_i32 s5, s5, 3
    s_sub_u32 s4, s4, s5
    s_cmp_eq_u32 s4, 1
    s_cselect_b32 s4, 3, 4
    s_cselect_b32 s5, 32, 8
    v_lshl_add_u32 v10, v6, s4, v5
    v_add_u32 v11, s5, v10
    s_lshl_b32 s4, s33, 2
    s_add_u32 s4, s4, 0
    s_mul_i32 s5, s4, 43691
    s_lshr_b32 s5, s5, 17
    s_mul_i32 s6, s5, 3
    s_sub_u32 s4, s4, s6
    s_and_b32 s6, s5, 1
    s_lshl_b32 s6, s6, 1
    s_add_u32 s4, s4, s6
    s_cmp_ge_u32 s4, 3
    s_cselect_b32 s6, 3, 0
    s_sub_u32 s4, s4, s6
    s_mul_i32 s6, s5, 54
    s_add_u32 s4, s4, s6
    s_mul_i32 s6, s34, 3
    s_add_u32 s4, s4, s6
    s_lshl_b32 s4, s4, 10
    s_add_u32 s40, s4, 8036352
    s_lshl_b32 s4, s33, 2
    s_add_u32 s4, s4, 1
    s_mul_i32 s5, s4, 43691
    s_lshr_b32 s5, s5, 17
    s_mul_i32 s6, s5, 3
    s_sub_u32 s4, s4, s6
    s_and_b32 s6, s5, 1
    s_lshl_b32 s6, s6, 1
    s_add_u32 s4, s4, s6
    s_cmp_ge_u32 s4, 3
    s_cselect_b32 s6, 3, 0
    s_sub_u32 s4, s4, s6
    s_mul_i32 s6, s5, 54
    s_add_u32 s4, s4, s6
    s_mul_i32 s6, s34, 3
    s_add_u32 s4, s4, s6
    s_lshl_b32 s4, s4, 10
    s_add_u32 s41, s4, 8036352
    s_lshl_b32 s4, s33, 2
    s_add_u32 s4, s4, 2
    s_mul_i32 s5, s4, 43691
    s_lshr_b32 s5, s5, 17
    s_mul_i32 s6, s5, 3
    s_sub_u32 s4, s4, s6
    s_and_b32 s6, s5, 1
    s_lshl_b32 s6, s6, 1
    s_add_u32 s4, s4, s6
    s_cmp_ge_u32 s4, 3
    s_cselect_b32 s6, 3, 0
    s_sub_u32 s4, s4, s6
    s_mul_i32 s6, s5, 54
    s_add_u32 s4, s4, s6
    s_mul_i32 s6, s34, 3
    s_add_u32 s4, s4, s6
    s_lshl_b32 s4, s4, 10
    s_add_u32 s42, s4, 8036352
    s_lshl_b32 s4, s33, 2
    s_add_u32 s4, s4, 3
    s_mul_i32 s5, s4, 43691
    s_lshr_b32 s5, s5, 17
    s_mul_i32 s6, s5, 3
    s_sub_u32 s4, s4, s6
    s_and_b32 s6, s5, 1
    s_lshl_b32 s6, s6, 1
    s_add_u32 s4, s4, s6
    s_cmp_ge_u32 s4, 3
    s_cselect_b32 s6, 3, 0
    s_sub_u32 s4, s4, s6
    s_mul_i32 s6, s5, 54
    s_add_u32 s4, s4, s6
    s_mul_i32 s6, s34, 3
    s_add_u32 s4, s4, s6
    s_lshl_b32 s4, s4, 10
    s_add_u32 s43, s4, 8036352
    s_waitcnt vmcnt(0)
    ds_read_b64_tr_b16 v[24:25], v8 offset:0
    ds_read_b64_tr_b16 v[26:27], v8 offset:512
    ds_read_b64_tr_b16 v[28:29], v9 offset:0
    ds_read_b64_tr_b16 v[30:31], v9 offset:512
    ds_read_b64_tr_b16 v[32:33], v10 offset:0
    ds_read_b64_tr_b16 v[34:35], v10 offset:512
    ds_read_b64_tr_b16 v[36:37], v11 offset:0
    ds_read_b64_tr_b16 v[38:39], v11 offset:512
    s_waitcnt lgkmcnt(4)
    ds_read_b64_tr_b16 v[40:41], v8 offset:4096
    ds_read_b64_tr_b16 v[42:43], v8 offset:4608
    ds_read_b64_tr_b16 v[44:45], v9 offset:4096
    ds_read_b64_tr_b16 v[46:47], v9 offset:4608
    ds_read_b64_tr_b16 v[48:49], v10 offset:4096
    ds_read_b64_tr_b16 v[50:51], v10 offset:4608
    ds_read_b64_tr_b16 v[52:53], v11 offset:4096
    ds_read_b64_tr_b16 v[54:55], v11 offset:4608
    s_waitcnt lgkmcnt(0)
s1_wo:
    s_and_b32 s24, s13, 3
    s_mul_i32 s25, s24, 9
    s_and_b32 s4, s24, 1
    s_add_u32 s25, s25, s4
    s_lshl_b32 s4, s20, 1
    s_add_u32 s25, s25, s4
    s_mul_i32 s16, s25, 18432
    s_add_u32 s16, s16, 2064384
    s_add_u32 s17, s16, 18432
    s_mov_b32 s5, 0
s1_wog:
    ds_read_b32 v4, v167 offset:520
    s_waitcnt lgkmcnt(0)
    v_readfirstlane_b32 s4, v4
    s_nop 0
    s_and_b32 s4, s4, 0x7040000
    s_cmp_eq_u32 s4, 0x7040000
    s_cbranch_scc1 s1_wog_ok
    s_sleep 1
    s_add_u32 s5, s5, 1
    s_cmp_lt_u32 s5, 0x40000
    s_cbranch_scc1 s1_wog
    s_endpgm
s1_wog_ok:
    buffer_load_dwordx4 v[56:59], v1, s[8:11], s16 offen offset:0 sc1
    buffer_load_dwordx4 v[60:63], v1, s[8:11], s17 offen offset:0 sc1
    buffer_load_dwordx4 v[64:67], v1, s[8:11], s16 offen offset:1024 sc1
    buffer_load_dwordx4 v[68:71], v1, s[8:11], s17 offen offset:1024 sc1
    buffer_load_dwordx4 v[72:75], v1, s[8:11], s16 offen offset:2048 sc1
    buffer_load_dwordx4 v[76:79], v1, s[8:11], s17 offen offset:2048 sc1
    buffer_load_dwordx4 v[80:83], v1, s[8:11], s16 offen offset:3072 sc1
    buffer_load_dwordx4 v[84:87], v1, s[8:11], s17 offen offset:3072 sc1
    s_add_u32 s16, s16, 4096
    s_add_u32 s17, s17, 4096
    buffer_load_dwordx4 v[88:91], v1, s[8:11], s16 offen offset:0 sc1
    buffer_load_dwordx4 v[92:95], v1, s[8:11], s17 offen offset:0 sc1
    buffer_load_dwordx4 v[96:99], v1, s[8:11], s16 offen offset:1024 sc1
    buffer_load_dwordx4 v[100:103], v1, s[8:11], s17 offen offset:1024 sc1
    s_branch s1_join
s1_done:
    s_waitcnt vmcnt(0)
s1_join:
    s_barrier
    s_cmp_ge_u32 s12, 8
    s_cbranch_scc1 s2_hi
    s_lshl_b32 s4, s86, 3
    s_add_u32 s5, s4, s13
    s_lshl_b32 s5, s5, 3
    s_add_u32 s5, s5, s12
    s_lshl_b32 s5, s5, 7
    s_add_u32 s5, s5, 27672576
    s_lshl_b32 s3, 1, s14
    s_add_u32 s40, s5, 0
    s_atomic_or s3, s[8:9], s40
    s_add_u32 s26, s4, s12
    s_lshl_b32 s26, s26, 3
    s_add_u32 s26, s26, s13
    s_lshl_b32 s26, s26, 7
    s_add_u32 s26, s26, 27672576
    s_and_b32 s4, s14, 0
    s_mul_i32 s4, s4, 16384
    s_add_u32 s26, s26, s4
    s_lshl_b32 s23, s14, 1
    s_lshr_b32 s4, s13, 2
    s_add_u32 s23, s23, s4
    s_lshl_b32 s23, s23, 3
    s_add_u32 s23, s23, s12
    s_mul_i32 s23, s23, 4608
    s_add_u32 s23, s23, s87
    s_add_u32 s23, s23, 22781952
    s_add_u32 s24, s23, 4096
    v_and_b32 v161, 3, v2
    v_lshrrev_b32 v156, 2, v2
    v_lshl_add_u32 v156, v161, 2, v156
    v_lshlrev_b32 v156, 6, v156
    v_lshl_add_u32 v156, v3, 4, v156
    v_min_u32 v161, 2, v161
    v_lshlrev_b32 v157, 6, v161
    v_lshl_add_u32 v157, v3, 4, v157
    v_mul_u32_u24 v159, 1536, v3
    v_lshl_add_u32 v158, v2, 3, v159
    v_lshl_add_u32 v159, v161, 3, v159
    s_mul_i32 s25, s12, 6144
    s_add_u32 s25, s25, 113664
    s_mul_i32 s22, s12, 6144
    s_add_u32 s22, s22, s96
    v_lshrrev_b32 v160, 5, v0
    v_mul_u32_u24 v160, 0, v160
    v_add_u32 v160, v160, v1
    v_add_u32 v156, s25, v156
    v_add_u32 v157, s25, v157
    v_add_u32 v158, s25, v158
    v_add_u32 v159, s25, v159
    s_mov_b32 s40, 0xffff
    s_mov_b32 s41, 0x0
    s_mov_b32 s42, 0xffff0000
    s_mov_b32 s43, 0x0
    s_mov_b32 s44, 0x0
    s_mov_b32 s45, 0xffff
    s_mov_b32 s46, 0x0
    s_mov_b32 s47, 0xffff0000
    s_mul_i32 s16, s13, 12
    s_add_u32 s16, s16, s28
    s_mul_i32 s16, s16, 55296
    s_mul_i32 s4, s19, 18432
    s_add_u32 s16, s16, s4
    s_add_u32 s16, s16, 2727936
    s_and_b32 s4, s13, 3
    s_mul_i32 s29, s4, 9
    s_and_b32 s4, s4, 1
    s_xor_b32 s4, s4, 1
    s_lshl_b32 s4, s4, 3
    s_add_u32 s29, s29, s4
    s_mul_i32 s4, s29, 18432
    s_add_u32 s4, s4, 2064384
    s_cmp_eq_u32 s12, 7
    s_cselect_b32 s16, s4, s16
    s_cmp_eq_u32 s12, 7
    s_cbranch_scc0 s2_n7a
    buffer_load_dwordx4 v[52:55], v1, s[8:11], s16 offen offset:0 sc1
    buffer_load_dwordx4 v[56:59], v1, s[8:11], s16 offen offset:1024 sc1
    buffer_load_dwordx4 v[60:63], v1, s[8:11], s16 offen offset:2048 sc1
    buffer_load_dwordx4 v[64:67], v1, s[8:11], s16 offen offset:3072 sc1
    s_add_u32 s16, s16, 4096
    buffer_load_dwordx4 v[68:71], v1, s[8:11], s16 offen offset:0 sc1
    buffer_load_dwordx4 v[72:75], v1, s[8:11], s16 offen offset:1024 sc1
    buffer_load_dwordx4 v[76:79], v1, s[8:11], s16 offen offset:2048 sc1
    buffer_load_dwordx4 v[80:83], v1, s[8:11], s16 offen offset:3072 sc1
    s_add_u32 s16, s16, 4096
    buffer_load_dwordx4 v[84:87], v1, s[8:11], s16 offen offset:0 sc1
    buffer_load_dwordx4 v[88:91], v1, s[8:11], s16 offen offset:1024 sc1
    buffer_load_dwordx4 v[92:95], v1, s[8:11], s16 offen offset:2048 sc1
    buffer_load_dwordx4 v[96:99], v1, s[8:11], s16 offen offset:3072 sc1
    s_add_u32 s16, s16, 4096
    buffer_load_dwordx4 v[100:103], v1, s[8:11], s16 offen offset:0 sc1
    buffer_load_dwordx4 v[104:107], v1, s[8:11], s16 offen offset:1024 sc1
    buffer_load_dwordx4 v[108:111], v1, s[8:11], s16 offen offset:2048 sc1
    buffer_load_dwordx4 v[112:115], v1, s[8:11], s16 offen offset:3072 sc1
    s_add_u32 s16, s16, 4096
    buffer_load_dwordx4 v[116:119], v1, s[8:11], s16 offen offset:0 sc1
    buffer_load_dwordx4 v[120:123], v1, s[8:11], s16 offen offset:1024 sc1
s2_n7a:
    s_mov_b32 s5, 0
e1a:
    s_sleep 2
    s_mov_b32 s6, 0
    s_atomic_or s6, s[8:9], s26 glc
    s_add_u32 s5, s5, 1
    s_cmp_lt_u32 s5, 0x40000
    s_cbranch_scc0 mega_end
    s_waitcnt lgkmcnt(0)
e1a_t:
    s_andn2_b32 s4, s3, s6
    s_cbranch_scc1 e1a
    v_lshlrev_b32 v161, 3, v0
    buffer_load_dwordx4 v[20:23], v1, s[8:11], s23 offen offset:0 sc1
    buffer_load_dwordx4 v[28:31], v1, s[8:11], s23 offen offset:1024 sc1
    buffer_load_dwordx4 v[36:39], v1, s[8:11], s23 offen offset:2048 sc1
    buffer_load_dwordx4 v[44:47], v1, s[8:11], s23 offen offset:3072 sc1
    buffer_load_dwordx2 v[162:163], v161, s[8:11], s24 offen sc1
    s_mov_b32 m0, s25
    s_branch e1b_t
e1b:
    s_sleep 2
    s_mov_b32 s6, 0
    s_atomic_or s6, s[8:9], s26 glc
    s_add_u32 s5, s5, 1
    s_cmp_lt_u32 s5, 0x40000
    s_cbranch_scc0 mega_end
    s_waitcnt lgkmcnt(0)
e1b_t:
    s_andn2_b32 s4, -1, s6
    s_cbranch_scc1 e1b
    buffer_load_dwordx4 v1, s[8:11], s22 offen offset:0 sc1 lds
    buffer_load_dwordx4 v160, s[8:11], s22 offen offset:1024 sc1 lds
    s_add_u32 s22, s22, 0
    buffer_load_dwordx4 v1, s[8:11], s22 offen offset:2048 sc1 lds
    s_add_u32 m0, s25, 3072
    s_add_u32 s22, s22, 3072
    buffer_load_dwordx4 v1, s[8:11], s22 offen offset:0 sc1 lds
    buffer_load_dwordx4 v160, s[8:11], s22 offen offset:1024 sc1 lds
    s_add_u32 s22, s22, 0
    buffer_load_dwordx4 v1, s[8:11], s22 offen offset:2048 sc1 lds
    s_waitcnt vmcnt(6)
    v_mov_b32 v24, v22
    v_mov_b32 v25, v23
    v_mov_b32 v22, v162
    v_mov_b32 v23, 0
    v_mov_b32 v26, v162
    v_mov_b32 v27, 0
    v_mov_b32 v32, v30
    v_mov_b32 v33, v31
    v_mov_b32 v30, v162
    v_mov_b32 v31, 0
    v_mov_b32 v34, v162
    v_mov_b32 v35, 0
    v_mov_b32 v40, v38
    v_mov_b32 v41, v39
    v_mov_b32 v38, v163
    v_mov_b32 v39, 0
    v_mov_b32 v42, v163
    v_mov_b32 v43, 0
    v_mov_b32 v48, v46
    v_mov_b32 v49, v47
    v_mov_b32 v46, v163
    v_mov_b32 v47, 0
    v_mov_b32 v50, v163
    v_mov_b32 v51, 0
    s_waitcnt vmcnt(0)
e1_d:
    ds_read_b64 v[4:5], v158 offset:1280
    ds_read_b64 v[6:7], v159 offset:1408
    ds_read_b128 v[124:127], v156 offset:0
    ds_read_b128 v[128:131], v157 offset:1024
    ds_read_b128 v[132:135], v156 offset:1536
    ds_read_b128 v[136:139], v157 offset:2560
    ds_read_b128 v[140:143], v156 offset:3072
    ds_read_b128 v[144:147], v157 offset:4096
    ds_read_b128 v[148:151], v156 offset:4608
    ds_read_b128 v[152:155], v157 offset:5632
    s_cmp_eq_u32 s12, 7
    s_cbranch_scc1 wld3706
    buffer_load_dwordx4 v[52:55], v1, s[8:11], s16 offen offset:0 sc1
    buffer_load_dwordx4 v[56:59], v1, s[8:11], s16 offen offset:1024 sc1
wld3706:
    s_waitcnt lgkmcnt(8)
    v_cvt_pk_bf16_f32 v4, v4, v5
    v_cvt_pk_bf16_f32 v6, v6, v7
    s_waitcnt lgkmcnt(6)
    v_cvt_pk_bf16_f32 v124, v124, v125
    v_cvt_pk_bf16_f32 v125, v126, v127
    v_cndmask_b32 v126, 0, v4, s[40:41]
    v_mov_b32 v127, 0
    v_cvt_pk_bf16_f32 v128, v128, v129
    v_cvt_pk_bf16_f32 v129, v130, v131
    v_cndmask_b32 v130, 0, v6, s[40:41]
    v_mov_b32 v131, 0
    s_waitcnt lgkmcnt(4)
    v_cvt_pk_bf16_f32 v132, v132, v133
    v_cvt_pk_bf16_f32 v133, v134, v135
    v_cndmask_b32 v134, 0, v4, s[42:43]
    v_mov_b32 v135, 0
    v_cvt_pk_bf16_f32 v136, v136, v137
    v_cvt_pk_bf16_f32 v137, v138, v139
    v_cndmask_b32 v138, 0, v6, s[42:43]
    v_mov_b32 v139, 0
    s_waitcnt lgkmcnt(2)
    v_cvt_pk_bf16_f32 v140, v140, v141
    v_cvt_pk_bf16_f32 v141, v142, v143
    v_cndmask_b32 v142, 0, v4, s[44:45]
    v_mov_b32 v143, 0
    v_cvt_pk_bf16_f32 v144, v144, v145
    v_cvt_pk_bf16_f32 v145, v146, v147
    v_cndmask_b32 v146, 0, v6, s[44:45]
    v_mov_b32 v147, 0
    s_waitcnt lgkmcnt(0)
    v_cvt_pk_bf16_f32 v148, v148, v149
    v_cvt_pk_bf16_f32 v149, v150, v151
    v_cndmask_b32 v150, 0, v4, s[46:47]
    v_mov_b32 v151, 0
    v_cvt_pk_bf16_f32 v152, v152, v153
    v_cvt_pk_bf16_f32 v153, v154, v155
    v_cndmask_b32 v154, 0, v6, s[46:47]
    v_mov_b32 v155, 0
    s_lshl_b32 s4, s12, 12
    s_add_u32 s4, s4, 76800
    v_add_u32 v156, s4, v1
    s_add_u32 s4, s21, 16
    s_lshl_b32 s4, s4, 11
    s_lshl_b32 s5, s20, 2
    s_add_u32 s4, s4, s5
    s_add_u32 s4, s4, 76800
    v_add_u32 v157, s4, v1
    v_mfma_f32_16x16x32_bf16 v[8:11], v[128:131], v[20:23], 0
    v_mfma_f32_16x16x32_bf16 v[16:19], v[136:139], v[24:27], 0
    v_mfma_f32_16x16x32_bf16 v[4:7], v[124:127], v[20:23], 0
    v_mfma_f32_16x16x32_bf16 v[12:15], v[132:135], v[24:27], 0
    s_cmp_eq_u32 s12, 7
    s_nop 0
    s_cbranch_scc1 wld3763
    buffer_load_dwordx4 v[60:63], v1, s[8:11], s16 offen offset:2048 sc1
wld3763:
    s_nop 1
    v_add_f32 v10, 0x358637bd, v10
    v_add_f32 v18, 0x358637bd, v18
    v_rcp_f32 v10, v10
    v_rcp_f32 v18, v18
    v_mul_f32 v8, v8, v10
    v_mul_f32 v9, v9, v10
    v_mul_f32 v4, v4, v10
    v_mul_f32 v5, v5, v10
    v_mul_f32 v6, v6, v10
    v_mul_f32 v7, v7, v10
    v_cvt_pk_bf16_f32 v20, v4, v5
    v_cvt_pk_bf16_f32 v21, v6, v7
    v_cvt_pk_bf16_f32 v160, v8, v9
    v_mul_f32 v16, v16, v18
    v_mul_f32 v17, v17, v18
    v_mul_f32 v12, v12, v18
    v_mul_f32 v13, v13, v18
    v_mul_f32 v14, v14, v18
    v_mul_f32 v15, v15, v18
    v_cvt_pk_bf16_f32 v22, v12, v13
    v_cvt_pk_bf16_f32 v23, v14, v15
    v_cvt_pk_bf16_f32 v161, v16, v17
    v_cndmask_b32 v160, v160, v161, s[42:43]
    ds_write_b128 v156, v[20:23] offset:0
    v_mfma_f32_16x16x32_bf16 v[8:11], v[144:147], v[28:31], 0
    v_mfma_f32_16x16x32_bf16 v[16:19], v[152:155], v[32:35], 0
    v_mfma_f32_16x16x32_bf16 v[4:7], v[140:143], v[28:31], 0
    v_mfma_f32_16x16x32_bf16 v[12:15], v[148:151], v[32:35], 0
    s_cmp_eq_u32 s12, 7
    s_nop 1
    s_cbranch_scc1 wld3795
    buffer_load_dwordx4 v[64:67], v1, s[8:11], s16 offen offset:3072 sc1
    s_add_u32 s16, s16, 4096
wld3795:
    s_nop 0
    v_add_f32 v10, 0x358637bd, v10
    v_add_f32 v18, 0x358637bd, v18
    v_rcp_f32 v10, v10
    v_rcp_f32 v18, v18
    v_mul_f32 v8, v8, v10
    v_mul_f32 v9, v9, v10
    v_mul_f32 v4, v4, v10
    v_mul_f32 v5, v5, v10
    v_mul_f32 v6, v6, v10
    v_mul_f32 v7, v7, v10
    v_cvt_pk_bf16_f32 v28, v4, v5
    v_cvt_pk_bf16_f32 v29, v6, v7
    v_cvt_pk_bf16_f32 v161, v8, v9
    v_cndmask_b32 v160, v160, v161, s[44:45]
    v_mul_f32 v16, v16, v18
    v_mul_f32 v17, v17, v18
    v_mul_f32 v12, v12, v18
    v_mul_f32 v13, v13, v18
    v_mul_f32 v14, v14, v18
    v_mul_f32 v15, v15, v18
    v_cvt_pk_bf16_f32 v30, v12, v13
    v_cvt_pk_bf16_f32 v31, v14, v15
    v_cvt_pk_bf16_f32 v161, v16, v17
    v_cndmask_b32 v160, v160, v161, s[46:47]
    ds_write_b128 v156, v[28:31] offset:2048
    ds_write_b32 v157, v160 offset:0
    v_mfma_f32_16x16x32_bf16 v[8:11], v[128:131], v[36:39], 0
    v_mfma_f32_16x16x32_bf16 v[16:19], v[136:139], v[40:43], 0
    v_mfma_f32_16x16x32_bf16 v[4:7], v[124:127], v[36:39], 0
    v_mfma_f32_16x16x32_bf16 v[12:15], v[132:135], v[40:43], 0
    s_cmp_eq_u32 s12, 7
    s_nop 0
    s_cbranch_scc1 wld3830
    buffer_load_dwordx4 v[68:71], v1, s[8:11], s16 offen offset:0 sc1
wld3830:
    s_nop 1
    v_add_f32 v10, 0x358637bd, v10
    v_add_f32 v18, 0x358637bd, v18
    v_rcp_f32 v10, v10
    v_rcp_f32 v18, v18
    v_mul_f32 v8, v8, v10
    v_mul_f32 v9, v9, v10
    v_mul_f32 v4, v4, v10
    v_mul_f32 v5, v5, v10
    v_mul_f32 v6, v6, v10
    v_mul_f32 v7, v7, v10
    v_cvt_pk_bf16_f32 v36, v4, v5
    v_cvt_pk_bf16_f32 v37, v6, v7
    v_cvt_pk_bf16_f32 v160, v8, v9
    v_mul_f32 v16, v16, v18
    v_mul_f32 v17, v17, v18
    v_mul_f32 v12, v12, v18
    v_mul_f32 v13, v13, v18
    v_mul_f32 v14, v14, v18
    v_mul_f32 v15, v15, v18
    v_cvt_pk_bf16_f32 v38, v12, v13
    v_cvt_pk_bf16_f32 v39, v14, v15
    v_cvt_pk_bf16_f32 v161, v16, v17
    v_cndmask_b32 v160, v160, v161, s[42:43]
    ds_write_b128 v156, v[36:39] offset:1024
    v_mfma_f32_16x16x32_bf16 v[8:11], v[144:147], v[44:47], 0
    v_mfma_f32_16x16x32_bf16 v[16:19], v[152:155], v[48:51], 0
    v_mfma_f32_16x16x32_bf16 v[4:7], v[140:143], v[44:47], 0
    v_mfma_f32_16x16x32_bf16 v[12:15], v[148:151], v[48:51], 0
    s_cmp_eq_u32 s12, 7
    s_nop 0
    s_cbranch_scc1 wld3862
    buffer_load_dwordx4 v[72:75], v1, s[8:11], s16 offen offset:1024 sc1
wld3862:
    s_nop 1
    v_add_f32 v10, 0x358637bd, v10
    v_add_f32 v18, 0x358637bd, v18
    v_rcp_f32 v10, v10
    v_rcp_f32 v18, v18
    v_mul_f32 v8, v8, v10
    v_mul_f32 v9, v9, v10
    v_mul_f32 v4, v4, v10
    v_mul_f32 v5, v5, v10
    v_mul_f32 v6, v6, v10
    v_mul_f32 v7, v7, v10
    v_cvt_pk_bf16_f32 v44, v4, v5
    v_cvt_pk_bf16_f32 v45, v6, v7
    v_cvt_pk_bf16_f32 v161, v8, v9
    v_cndmask_b32 v160, v160, v161, s[44:45]
    v_mul_f32 v16, v16, v18
    v_mul_f32 v17, v17, v18
    v_mul_f32 v12, v12, v18
    v_mul_f32 v13, v13, v18
    v_mul_f32 v14, v14, v18
    v_mul_f32 v15, v15, v18
    v_cvt_pk_bf16_f32 v46, v12, v13
    v_cvt_pk_bf16_f32 v47, v14, v15
    v_cvt_pk_bf16_f32 v161, v16, v17
    v_cndmask_b32 v160, v160, v161, s[46:47]
    ds_write_b128 v156, v[44:47] offset:3072
    ds_write_b32 v157, v160 offset:1024
    s_waitcnt lgkmcnt(0)
    s_barrier
    s_cmp_eq_u32 s12, 7
    s_cbranch_scc1 s2_w7
    s_barrier
    buffer_load_dwordx4 v[76:79], v1, s[8:11], s16 offen offset:2048 sc1
    buffer_load_dwordx4 v[80:83], v1, s[8:11], s16 offen offset:3072 sc1
    s_add_u32 s16, s16, 4096
    buffer_load_dwordx4 v[84:87], v1, s[8:11], s16 offen offset:0 sc1
    buffer_load_dwordx4 v[88:91], v1, s[8:11], s16 offen offset:1024 sc1
    buffer_load_dwordx4 v[92:95], v1, s[8:11], s16 offen offset:2048 sc1
    buffer_load_dwordx4 v[96:99], v1, s[8:11], s16 offen offset:3072 sc1
    s_add_u32 s16, s16, 4096
    s_branch s2_done
s2_w7:
    s_setprio 3
    v_add_u32 v156, 76800, v1
    ds_read_b128 v[124:127], v156 offset:0
    ds_read_b128 v[128:131], v156 offset:1024
    ds_read_b128 v[132:135], v156 offset:2048
    ds_read_b128 v[136:139], v156 offset:3072
    ds_read_b128 v[140:143], v156 offset:4096
    ds_read_b128 v[144:147], v156 offset:5120
    ds_read_b128 v[148:151], v156 offset:6144
    ds_read_b128 v[152:155], v156 offset:7168
    s_waitcnt lgkmcnt(7)
    s_barrier
    v_mfma_f32_16x16x32_bf16 v[4:7], v[52:55], v[124:127], 0
    ds_read_b128 v[124:127], v156 offset:8192
    s_waitcnt lgkmcnt(7)
    v_mfma_f32_16x16x32_bf16 v[8:11], v[52:55], v[128:131], 0
    ds_read_b128 v[128:131], v156 offset:9216
    s_waitcnt lgkmcnt(7)
    v_mfma_f32_16x16x32_bf16 v[4:7], v[56:59], v[132:135], v[4:7]
    ds_read_b128 v[132:135], v156 offset:10240
    s_waitcnt lgkmcnt(7)
    v_mfma_f32_16x16x32_bf16 v[8:11], v[56:59], v[136:139], v[8:11]
    ds_read_b128 v[136:139], v156 offset:11264
    s_waitcnt lgkmcnt(7)
    v_mfma_f32_16x16x32_bf16 v[4:7], v[60:63], v[140:143], v[4:7]
    ds_read_b128 v[140:143], v156 offset:12288
    s_waitcnt lgkmcnt(7)
    v_mfma_f32_16x16x32_bf16 v[8:11], v[60:63], v[144:147], v[8:11]
    ds_read_b128 v[144:147], v156 offset:13312
    s_waitcnt lgkmcnt(7)
    v_mfma_f32_16x16x32_bf16 v[4:7], v[64:67], v[148:151], v[4:7]
    ds_read_b128 v[148:151], v156 offset:14336
    s_waitcnt lgkmcnt(7)
    v_mfma_f32_16x16x32_bf16 v[8:11], v[64:67], v[152:155], v[8:11]
    ds_read_b128 v[152:155], v156 offset:15360
    s_waitcnt lgkmcnt(7)
    v_mfma_f32_16x16x32_bf16 v[4:7], v[68:71], v[124:127], v[4:7]
    ds_read_b128 v[124:127], v156 offset:16384
    s_waitcnt lgkmcnt(7)
    v_mfma_f32_16x16x32_bf16 v[8:11], v[68:71], v[128:131], v[8:11]
    ds_read_b128 v[128:131], v156 offset:17408
    s_waitcnt lgkmcnt(7)
    v_mfma_f32_16x16x32_bf16 v[4:7], v[72:75], v[132:135], v[4:7]
    ds_read_b128 v[132:135], v156 offset:18432
    s_waitcnt lgkmcnt(7)
    v_mfma_f32_16x16x32_bf16 v[8:11], v[72:75], v[136:139], v[8:11]
    ds_read_b128 v[136:139], v156 offset:19456
    s_waitcnt lgkmcnt(7)
    v_mfma_f32_16x16x32_bf16 v[4:7], v[76:79], v[140:143], v[4:7]
    ds_read_b128 v[140:143], v156 offset:20480
    s_waitcnt lgkmcnt(7)
    v_mfma_f32_16x16x32_bf16 v[8:11], v[76:79], v[144:147], v[8:11]
    ds_read_b128 v[144:147], v156 offset:21504
    s_waitcnt lgkmcnt(7)
    v_mfma_f32_16x16x32_bf16 v[4:7], v[80:83], v[148:151], v[4:7]
    ds_read_b128 v[148:151], v156 offset:22528
    s_waitcnt lgkmcnt(7)
    v_mfma_f32_16x16x32_bf16 v[8:11], v[80:83], v[152:155], v[8:11]
    ds_read_b128 v[152:155], v156 offset:23552
    s_waitcnt lgkmcnt(7)
    v_mfma_f32_16x16x32_bf16 v[4:7], v[84:87], v[124:127], v[4:7]
    ds_read_b128 v[124:127], v156 offset:24576
    s_waitcnt lgkmcnt(7)
    v_mfma_f32_16x16x32_bf16 v[8:11], v[84:87], v[128:131], v[8:11]
    ds_read_b128 v[128:131], v156 offset:25600
    s_waitcnt lgkmcnt(7)
    v_mfma_f32_16x16x32_bf16 v[4:7], v[88:91], v[132:135], v[4:7]
    ds_read_b128 v[132:135], v156 offset:26624
    s_waitcnt lgkmcnt(7)
    v_mfma_f32_16x16x32_bf16 v[8:11], v[88:91], v[136:139], v[8:11]
    ds_read_b128 v[136:139], v156 offset:27648
    s_waitcnt lgkmcnt(7)
    v_mfma_f32_16x16x32_bf16 v[4:7], v[92:95], v[140:143], v[4:7]
    ds_read_b128 v[140:143], v156 offset:28672
    s_waitcnt lgkmcnt(7)
    v_mfma_f32_16x16x32_bf16 v[8:11], v[92:95], v[144:147], v[8:11]
    ds_read_b128 v[144:147], v156 offset:29696
    s_waitcnt lgkmcnt(7)
    v_mfma_f32_16x16x32_bf16 v[4:7], v[96:99], v[148:151], v[4:7]
    ds_read_b128 v[148:151], v156 offset:30720
    s_waitcnt lgkmcnt(7)
    v_mfma_f32_16x16x32_bf16 v[8:11], v[96:99], v[152:155], v[8:11]
    ds_read_b128 v[152:155], v156 offset:31744
    s_waitcnt lgkmcnt(7)
    v_mfma_f32_16x16x32_bf16 v[4:7], v[100:103], v[124:127], v[4:7]
    ds_read_b128 v[124:127], v156 offset:32768
    s_waitcnt lgkmcnt(7)
    v_mfma_f32_16x16x32_bf16 v[8:11], v[100:103], v[128:131], v[8:11]
    ds_read_b128 v[128:131], v156 offset:33792
    s_waitcnt lgkmcnt(7)
    v_mfma_f32_16x16x32_bf16 v[4:7], v[104:107], v[132:135], v[4:7]
    ds_read_b128 v[132:135], v156 offset:34816
    s_waitcnt lgkmcnt(7)
    v_mfma_f32_16x16x32_bf16 v[8:11], v[104:107], v[136:139], v[8:11]
    ds_read_b128 v[136:139], v156 offset:35840
    s_waitcnt lgkmcnt(7)
    v_mfma_f32_16x16x32_bf16 v[4:7], v[108:111], v[140:143], v[4:7]
    s_waitcnt lgkmcnt(6)
    v_mfma_f32_16x16x32_bf16 v[8:11], v[108:111], v[144:147], v[8:11]
    s_waitcnt lgkmcnt(5)
    v_mfma_f32_16x16x32_bf16 v[4:7], v[112:115], v[148:151], v[4:7]
    s_waitcnt lgkmcnt(4)
    v_mfma_f32_16x16x32_bf16 v[8:11], v[112:115], v[152:155], v[8:11]
    s_waitcnt lgkmcnt(3)
    v_mfma_f32_16x16x32_bf16 v[4:7], v[116:119], v[124:127], v[4:7]
    s_waitcnt lgkmcnt(2)
    v_mfma_f32_16x16x32_bf16 v[8:11], v[116:119], v[128:131], v[8:11]
    s_waitcnt lgkmcnt(1)
    v_mfma_f32_16x16x32_bf16 v[4:7], v[120:123], v[132:135], v[4:7]
    s_waitcnt lgkmcnt(0)
    v_mfma_f32_16x16x32_bf16 v[8:11], v[120:123], v[136:139], v[8:11]
    s_bfe_u32 s7, s29, 0x10001
    s_and_b32 s24, s29, 1
    s_lshl_b32 s24, s24, 1
    v_lshrrev_b32 v46, 1, v3
    v_add_u32 v46, s24, v46
    v_lshlrev_b32 v47, 8, v46
    v_lshl_add_u32 v47, v2, 4, v47
    s_lshl_b32 s4, s7, 10
    v_add_u32 v44, s4, v47
    s_cmp_eq_u32 s86, 0
    s_cbranch_scc0 lp4025
    s_lshl_b32 s4, s7, 2
    v_add_u32 v44, s4, v46
    v_and_b32 v45, 7, v2
    v_xor_b32 v44, v44, v45
    v_lshlrev_b32 v44, 4, v44
    v_lshl_add_u32 v44, v2, 7, v44
lp4025:
    v_and_b32 v46, 1, v3
    v_lshl_add_u32 v44, v46, 11, v44
    v_mul_u32_u24 v46, 18432, v46
    v_add_u32 v46, v46, v47
    s_lshr_b32 s4, s29, 1
    s_lshr_b32 s5, s13, 2
    s_lshl_b32 s5, s5, 1
    s_lshr_b32 s6, s4, 1
    s_lshl_b32 s6, s6, 2
    s_add_u32 s6, s6, s5
    s_lshl_b32 s6, s6, 11
    s_add_u32 s6, s6, 3072
    v_add_u32 v44, s6, v44
    ds_read_b128 v[20:23], v44 offset:0
    s_lshl_b32 s6, s14, 2
    s_add_u32 s6, s6, s5
    s_mul_i32 s6, s6, 18
    s_add_u32 s6, s6, s4
    s_lshl_b32 s6, s6, 10
    s_add_u32 s6, s6, s87
    s_add_u32 s6, s6, 18063360
    s_add_u32 s7, s6, 18432
    v_permlane16_swap_b32 v4, v8
    v_permlane16_swap_b32 v5, v9
    v_permlane16_swap_b32 v6, v10
    v_permlane16_swap_b32 v7, v11
    s_waitcnt lgkmcnt(0)
    v_lshlrev_b32 v28, 16, v20
    v_and_b32 v29, 0xffff0000, v20
    v_lshlrev_b32 v30, 16, v21
    v_and_b32 v31, 0xffff0000, v21
    v_lshlrev_b32 v32, 16, v22
    v_and_b32 v33, 0xffff0000, v22
    v_lshlrev_b32 v34, 16, v23
    v_and_b32 v35, 0xffff0000, v23
    v_add_f32 v28, v28, v4
    v_add_f32 v29, v29, v5
    v_add_f32 v30, v30, v6
    v_add_f32 v31, v31, v7
    v_add_f32 v32, v32, v8
    v_add_f32 v33, v33, v9
    v_add_f32 v34, v34, v10
    v_add_f32 v35, v35, v11
    v_cvt_pk_bf16_f32 v20, v28, v29
    v_cvt_pk_bf16_f32 v21, v30, v31
    v_cvt_pk_bf16_f32 v22, v32, v33
    v_cvt_pk_bf16_f32 v23, v34, v35
    buffer_store_dwordx4 v[20:23], v46, s[8:11], s6 offen sc1
    s_setprio 0
    s_waitcnt vmcnt(0)
    s_branch s2_done
s2_hi:
    s_cmp_eq_u32 s35, 0
    s_cbranch_scc1 w2_s1
    buffer_store_dwordx4 v[24:27], v1, s[8:11], s40 offen offset:0 sc1
    buffer_store_dwordx4 v[28:31], v1, s[8:11], s41 offen offset:0 sc1
    buffer_store_dwordx4 v[32:35], v1, s[8:11], s42 offen offset:0 sc1
    buffer_store_dwordx4 v[36:39], v1, s[8:11], s43 offen offset:0 sc1
    buffer_store_dwordx4 v[40:43], v1, s[8:11], s40 offen offset:3072 sc1
    buffer_store_dwordx4 v[44:47], v1, s[8:11], s41 offen offset:3072 sc1
    buffer_store_dwordx4 v[48:51], v1, s[8:11], s42 offen offset:3072 sc1
    buffer_store_dwordx4 v[52:55], v1, s[8:11], s43 offen offset:3072 sc1
w2_s1:
    buffer_load_dwordx4 v[104:107], v1, s[8:11], s16 offen offset:2048 sc1
    buffer_load_dwordx4 v[108:111], v1, s[8:11], s17 offen offset:2048 sc1
    buffer_load_dwordx4 v[112:115], v1, s[8:11], s16 offen offset:3072 sc1
    buffer_load_dwordx4 v[116:119], v1, s[8:11], s17 offen offset:3072 sc1
    s_add_u32 s16, s16, 4096
    s_add_u32 s17, s17, 4096
    buffer_load_dwordx4 v[120:123], v1, s[8:11], s16 offen offset:0 sc1
    buffer_load_dwordx4 v[124:127], v1, s[8:11], s17 offen offset:0 sc1
    buffer_load_dwordx4 v[128:131], v1, s[8:11], s16 offen offset:1024 sc1
    buffer_load_dwordx4 v[132:135], v1, s[8:11], s17 offen offset:1024 sc1
    buffer_load_dwordx4 v[136:139], v1, s[8:11], s16 offen offset:2048 sc1
    buffer_load_dwordx4 v[140:143], v1, s[8:11], s17 offen offset:2048 sc1
    buffer_load_dwordx4 v[144:147], v1, s[8:11], s16 offen offset:3072 sc1
    buffer_load_dwordx4 v[148:151], v1, s[8:11], s17 offen offset:3072 sc1
    s_add_u32 s16, s16, 4096
    s_add_u32 s17, s17, 4096
    buffer_load_dwordx4 v[152:155], v1, s[8:11], s16 offen offset:0 sc1
    buffer_load_dwordx4 v[156:159], v1, s[8:11], s17 offen offset:0 sc1
    v_min_u32 v6, 39, v0
    v_lshlrev_b32 v6, 7, v6
    buffer_load_dword v7, v6, s[8:11], s16 offen offset:1024
    buffer_load_dword v7, v6, s[8:11], s17 offen offset:1024
    v_lshlrev_b32 v4, 2, v0
    s_mov_b64 exec, 0xff
    ds_write_b32 v4, v167 offset:512
    s_mov_b64 exec, -1
    s_waitcnt lgkmcnt(0)
    v_add_u32 v4, 76800, v1
    s_waitcnt vmcnt(0)
    s_setprio 2
    s_barrier
    ds_read_b128 v[24:27], v4 offset:0
    ds_read_b128 v[28:31], v4 offset:1024
    ds_read_b128 v[32:35], v4 offset:2048
    ds_read_b128 v[36:39], v4 offset:3072
    ds_read_b128 v[40:43], v4 offset:4096
    ds_read_b128 v[44:47], v4 offset:5120
    ds_read_b128 v[48:51], v4 offset:6144
    ds_read_b128 v[52:55], v4 offset:7168
    s_waitcnt lgkmcnt(6)
    v_mfma_f32_16x16x32_bf16 v[8:11], v[56:59], v[24:27], 0
    v_mfma_f32_16x16x32_bf16 v[12:15], v[56:59], v[28:31], 0
    v_mfma_f32_16x16x32_bf16 v[16:19], v[60:63], v[24:27], 0
    v_mfma_f32_16x16x32_bf16 v[20:23], v[60:63], v[28:31], 0
    buffer_load_dwordx4 v[56:59], v1, s[8:11], s16 offen offset:1024 sc1
    buffer_load_dwordx4 v[60:63], v1, s[8:11], s17 offen offset:1024 sc1
    ds_read_b128 v[24:27], v4 offset:8192
    ds_read_b128 v[28:31], v4 offset:9216
    s_waitcnt lgkmcnt(6)
    v_mfma_f32_16x16x32_bf16 v[8:11], v[64:67], v[32:35], v[8:11]
    v_mfma_f32_16x16x32_bf16 v[12:15], v[64:67], v[36:39], v[12:15]
    v_mfma_f32_16x16x32_bf16 v[16:19], v[68:71], v[32:35], v[16:19]
    v_mfma_f32_16x16x32_bf16 v[20:23], v[68:71], v[36:39], v[20:23]
    buffer_load_dwordx4 v[64:67], v1, s[8:11], s16 offen offset:2048 sc1
    buffer_load_dwordx4 v[68:71], v1, s[8:11], s17 offen offset:2048 sc1
    ds_read_b128 v[32:35], v4 offset:10240
    ds_read_b128 v[36:39], v4 offset:11264
    s_waitcnt lgkmcnt(6)
    v_mfma_f32_16x16x32_bf16 v[8:11], v[72:75], v[40:43], v[8:11]
    v_mfma_f32_16x16x32_bf16 v[12:15], v[72:75], v[44:47], v[12:15]
    v_mfma_f32_16x16x32_bf16 v[16:19], v[76:79], v[40:43], v[16:19]
    v_mfma_f32_16x16x32_bf16 v[20:23], v[76:79], v[44:47], v[20:23]
    buffer_load_dwordx4 v[72:75], v1, s[8:11], s16 offen offset:3072 sc1
    buffer_load_dwordx4 v[76:79], v1, s[8:11], s17 offen offset:3072 sc1
    s_add_u32 s16, s16, 4096
    s_add_u32 s17, s17, 4096
    ds_read_b128 v[40:43], v4 offset:12288
    ds_read_b128 v[44:47], v4 offset:13312
    s_waitcnt lgkmcnt(6)
    v_mfma_f32_16x16x32_bf16 v[8:11], v[80:83], v[48:51], v[8:11]
    v_mfma_f32_16x16x32_bf16 v[12:15], v[80:83], v[52:55], v[12:15]
    v_mfma_f32_16x16x32_bf16 v[16:19], v[84:87], v[48:51], v[16:19]
    v_mfma_f32_16x16x32_bf16 v[20:23], v[84:87], v[52:55], v[20:23]
    buffer_load_dwordx4 v[80:83], v1, s[8:11], s16 offen offset:0 sc1
    buffer_load_dwordx4 v[84:87], v1, s[8:11], s17 offen offset:0 sc1
    ds_read_b128 v[48:51], v4 offset:14336
    ds_read_b128 v[52:55], v4 offset:15360
    s_waitcnt lgkmcnt(6)
    v_mfma_f32_16x16x32_bf16 v[8:11], v[88:91], v[24:27], v[8:11]
    v_mfma_f32_16x16x32_bf16 v[12:15], v[88:91], v[28:31], v[12:15]
    v_mfma_f32_16x16x32_bf16 v[16:19], v[92:95], v[24:27], v[16:19]
    v_mfma_f32_16x16x32_bf16 v[20:23], v[92:95], v[28:31], v[20:23]
    buffer_load_dwordx4 v[88:91], v1, s[8:11], s16 offen offset:1024 sc1
    buffer_load_dwordx4 v[92:95], v1, s[8:11], s17 offen offset:1024 sc1
    s_barrier
    ds_read_b128 v[24:27], v4 offset:16384
    ds_read_b128 v[28:31], v4 offset:17408
    s_waitcnt lgkmcnt(6)
    v_mfma_f32_16x16x32_bf16 v[8:11], v[96:99], v[32:35], v[8:11]
    v_mfma_f32_16x16x32_bf16 v[12:15], v[96:99], v[36:39], v[12:15]
    v_mfma_f32_16x16x32_bf16 v[16:19], v[100:103], v[32:35], v[16:19]
    v_mfma_f32_16x16x32_bf16 v[20:23], v[100:103], v[36:39], v[20:23]
    ds_read_b128 v[32:35], v4 offset:18432
    ds_read_b128 v[36:39], v4 offset:19456
    s_waitcnt lgkmcnt(6)
    v_mfma_f32_16x16x32_bf16 v[8:11], v[104:107], v[40:43], v[8:11]
    v_mfma_f32_16x16x32_bf16 v[12:15], v[104:107], v[44:47], v[12:15]
    v_mfma_f32_16x16x32_bf16 v[16:19], v[108:111], v[40:43], v[16:19]
    v_mfma_f32_16x16x32_bf16 v[20:23], v[108:111], v[44:47], v[20:23]
    ds_read_b128 v[40:43], v4 offset:20480
    ds_read_b128 v[44:47], v4 offset:21504
    s_waitcnt lgkmcnt(6)
    v_mfma_f32_16x16x32_bf16 v[8:11], v[112:115], v[48:51], v[8:11]
    v_mfma_f32_16x16x32_bf16 v[12:15], v[112:115], v[52:55], v[12:15]
    v_mfma_f32_16x16x32_bf16 v[16:19], v[116:119], v[48:51], v[16:19]
    v_mfma_f32_16x16x32_bf16 v[20:23], v[116:119], v[52:55], v[20:23]
    ds_read_b128 v[48:51], v4 offset:22528
    ds_read_b128 v[52:55], v4 offset:23552
    s_waitcnt lgkmcnt(6)
    v_mfma_f32_16x16x32_bf16 v[8:11], v[120:123], v[24:27], v[8:11]
    v_mfma_f32_16x16x32_bf16 v[12:15], v[120:123], v[28:31], v[12:15]
    v_mfma_f32_16x16x32_bf16 v[16:19], v[124:127], v[24:27], v[16:19]
    v_mfma_f32_16x16x32_bf16 v[20:23], v[124:127], v[28:31], v[20:23]
    ds_read_b128 v[24:27], v4 offset:24576
    ds_read_b128 v[28:31], v4 offset:25600
    s_waitcnt lgkmcnt(6)
    v_mfma_f32_16x16x32_bf16 v[8:11], v[128:131], v[32:35], v[8:11]
    v_mfma_f32_16x16x32_bf16 v[12:15], v[128:131], v[36:39], v[12:15]
    v_mfma_f32_16x16x32_bf16 v[16:19], v[132:135], v[32:35], v[16:19]
    v_mfma_f32_16x16x32_bf16 v[20:23], v[132:135], v[36:39], v[20:23]
    ds_read_b128 v[32:35], v4 offset:26624
    ds_read_b128 v[36:39], v4 offset:27648
    s_waitcnt lgkmcnt(6)
    v_mfma_f32_16x16x32_bf16 v[8:11], v[136:139], v[40:43], v[8:11]
    v_mfma_f32_16x16x32_bf16 v[12:15], v[136:139], v[44:47], v[12:15]
    v_mfma_f32_16x16x32_bf16 v[16:19], v[140:143], v[40:43], v[16:19]
    v_mfma_f32_16x16x32_bf16 v[20:23], v[140:143], v[44:47], v[20:23]
    ds_read_b128 v[40:43], v4 offset:28672
    ds_read_b128 v[44:47], v4 offset:29696
    s_waitcnt lgkmcnt(6)
    v_mfma_f32_16x16x32_bf16 v[8:11], v[144:147], v[48:51], v[8:11]
    v_mfma_f32_16x16x32_bf16 v[12:15], v[144:147], v[52:55], v[12:15]
    v_mfma_f32_16x16x32_bf16 v[16:19], v[148:151], v[48:51], v[16:19]
    v_mfma_f32_16x16x32_bf16 v[20:23], v[148:151], v[52:55], v[20:23]
    ds_read_b128 v[48:51], v4 offset:30720
    ds_read_b128 v[52:55], v4 offset:31744
    s_waitcnt lgkmcnt(6)
    v_mfma_f32_16x16x32_bf16 v[8:11], v[152:155], v[24:27], v[8:11]
    v_mfma_f32_16x16x32_bf16 v[12:15], v[152:155], v[28:31], v[12:15]
    v_mfma_f32_16x16x32_bf16 v[16:19], v[156:159], v[24:27], v[16:19]
    v_mfma_f32_16x16x32_bf16 v[20:23], v[156:159], v[28:31], v[20:23]
    ds_read_b128 v[24:27], v4 offset:32768
    ds_read_b128 v[28:31], v4 offset:33792
    s_waitcnt lgkmcnt(6) vmcnt(8)
    v_mfma_f32_16x16x32_bf16 v[8:11], v[56:59], v[32:35], v[8:11]
    v_mfma_f32_16x16x32_bf16 v[12:15], v[56:59], v[36:39], v[12:15]
    v_mfma_f32_16x16x32_bf16 v[16:19], v[60:63], v[32:35], v[16:19]
    v_mfma_f32_16x16x32_bf16 v[20:23], v[60:63], v[36:39], v[20:23]
    ds_read_b128 v[32:35], v4 offset:34816
    ds_read_b128 v[36:39], v4 offset:35840
    s_waitcnt lgkmcnt(6) vmcnt(6)
    v_mfma_f32_16x16x32_bf16 v[8:11], v[64:67], v[40:43], v[8:11]
    v_mfma_f32_16x16x32_bf16 v[12:15], v[64:67], v[44:47], v[12:15]
    v_mfma_f32_16x16x32_bf16 v[16:19], v[68:71], v[40:43], v[16:19]
    v_mfma_f32_16x16x32_bf16 v[20:23], v[68:71], v[44:47], v[20:23]
    s_waitcnt lgkmcnt(4) vmcnt(4)
    v_mfma_f32_16x16x32_bf16 v[8:11], v[72:75], v[48:51], v[8:11]
    v_mfma_f32_16x16x32_bf16 v[12:15], v[72:75], v[52:55], v[12:15]
    v_mfma_f32_16x16x32_bf16 v[16:19], v[76:79], v[48:51], v[16:19]
    v_mfma_f32_16x16x32_bf16 v[20:23], v[76:79], v[52:55], v[20:23]
    s_waitcnt lgkmcnt(2) vmcnt(2)
    v_mfma_f32_16x16x32_bf16 v[8:11], v[80:83], v[24:27], v[8:11]
    v_mfma_f32_16x16x32_bf16 v[12:15], v[80:83], v[28:31], v[12:15]
    v_mfma_f32_16x16x32_bf16 v[16:19], v[84:87], v[24:27], v[16:19]
    v_mfma_f32_16x16x32_bf16 v[20:23], v[84:87], v[28:31], v[20:23]
    s_waitcnt lgkmcnt(0) vmcnt(0)
    v_mfma_f32_16x16x32_bf16 v[8:11], v[88:91], v[32:35], v[8:11]
    v_mfma_f32_16x16x32_bf16 v[12:15], v[88:91], v[36:39], v[12:15]
    v_mfma_f32_16x16x32_bf16 v[16:19], v[92:95], v[32:35], v[16:19]
    v_mfma_f32_16x16x32_bf16 v[20:23], v[92:95], v[36:39], v[20:23]
    s_bfe_u32 s7, s25, 0x10001
    s_lshl_b32 s4, s7, 10
    v_add_u32 v48, s4, v1
    s_cmp_eq_u32 s86, 0
    s_cbranch_scc0 lp4270
    s_lshl_b32 s4, s7, 2
    v_add_u32 v48, s4, v3
    v_and_b32 v49, 7, v2
    v_xor_b32 v48, v48, v49
    v_lshlrev_b32 v48, 4, v48
    v_lshl_add_u32 v48, v2, 7, v48
lp4270:
    s_lshr_b32 s4, s25, 1
    s_lshr_b32 s5, s13, 2
    s_lshl_b32 s5, s5, 1
    s_lshr_b32 s6, s4, 1
    s_lshl_b32 s6, s6, 2
    s_add_u32 s6, s6, s5
    s_lshl_b32 s6, s6, 11
    s_add_u32 s6, s6, 3072
    v_add_u32 v48, s6, v48
    ds_read_b128 v[24:27], v48 offset:0
    ds_read_b128 v[28:31], v48 offset:2048
    s_lshl_b32 s6, s14, 2
    s_add_u32 s6, s6, s5
    s_mul_i32 s6, s6, 18
    s_add_u32 s6, s6, s4
    s_lshl_b32 s6, s6, 10
    s_add_u32 s6, s6, s87
    s_add_u32 s6, s6, 18063360
    s_add_u32 s7, s6, 18432
    s_waitcnt lgkmcnt(0)
    v_lshlrev_b32 v32, 16, v24
    v_and_b32 v33, 0xffff0000, v24
    v_lshlrev_b32 v34, 16, v25
    v_and_b32 v35, 0xffff0000, v25
    v_lshlrev_b32 v36, 16, v26
    v_and_b32 v37, 0xffff0000, v26
    v_lshlrev_b32 v38, 16, v27
    v_and_b32 v39, 0xffff0000, v27
    v_add_f32 v32, v32, v8
    v_add_f32 v33, v33, v9
    v_add_f32 v34, v34, v10
    v_add_f32 v35, v35, v11
    v_add_f32 v36, v36, v16
    v_add_f32 v37, v37, v17
    v_add_f32 v38, v38, v18
    v_add_f32 v39, v39, v19
    v_cvt_pk_bf16_f32 v24, v32, v33
    v_cvt_pk_bf16_f32 v25, v34, v35
    v_cvt_pk_bf16_f32 v26, v36, v37
    v_cvt_pk_bf16_f32 v27, v38, v39
    buffer_store_dwordx4 v[24:27], v1, s[8:11], s6 offen sc1
    v_lshlrev_b32 v40, 16, v28
    v_and_b32 v41, 0xffff0000, v28
    v_lshlrev_b32 v42, 16, v29
    v_and_b32 v43, 0xffff0000, v29
    v_lshlrev_b32 v44, 16, v30
    v_and_b32 v45, 0xffff0000, v30
    v_lshlrev_b32 v46, 16, v31
    v_and_b32 v47, 0xffff0000, v31
    v_add_f32 v40, v40, v12
    v_add_f32 v41, v41, v13
    v_add_f32 v42, v42, v14
    v_add_f32 v43, v43, v15
    v_add_f32 v44, v44, v20
    v_add_f32 v45, v45, v21
    v_add_f32 v46, v46, v22
    v_add_f32 v47, v47, v23
    v_cvt_pk_bf16_f32 v28, v40, v41
    v_cvt_pk_bf16_f32 v29, v42, v43
    v_cvt_pk_bf16_f32 v30, v44, v45
    v_cvt_pk_bf16_f32 v31, v46, v47
    buffer_store_dwordx4 v[28:31], v1, s[8:11], s7 offen sc1
    s_setprio 0
    s_waitcnt vmcnt(0)
    s_cmp_eq_u32 s35, 0
    s_cbranch_scc1 s2_done
    s_mov_b32 s3, 1
    s_atomic_add s3, s[8:9], s35
s2_done:
    s_add_u32 s89, s89, 8
    s_barrier
    s_cmp_eq_u32 s12, 11
    s_cbranch_scc0 e2_go
    v_mov_b32 v4, 1
    s_mov_b32 s5, 0
    s_mov_b32 s4, 1
    s_atomic_add s4, s[8:9], s88 glc
    s_waitcnt lgkmcnt(0)
    s_add_u32 s4, s4, 1
    s_cmp_ge_u32 s4, s89
    s_cbranch_scc1 e2_ok
e2:
    s_mov_b32 s4, 0
    s_atomic_add s4, s[8:9], s88 glc
    s_waitcnt lgkmcnt(0)
    s_cmp_ge_u32 s4, s89
    s_cbranch_scc1 e2_ok
    s_add_u32 s5, s5, 1
    s_cmp_lt_u32 s5, 0x40000
    s_cbranch_scc1 e2
    s_endpgm
e2_ok:
e2_go:
    s_cmp_ge_u32 s12, 7
    s_cbranch_scc1 e2_y
    buffer_load_dwordx4 v[100:103], v1, s[8:11], s16 offen offset:0 sc1
    buffer_load_dwordx4 v[104:107], v1, s[8:11], s16 offen offset:1024 sc1
    buffer_load_dwordx4 v[108:111], v1, s[8:11], s16 offen offset:2048 sc1
    buffer_load_dwordx4 v[112:115], v1, s[8:11], s16 offen offset:3072 sc1
    s_add_u32 s16, s16, 4096
    buffer_load_dwordx4 v[116:119], v1, s[8:11], s16 offen offset:0 sc1
    buffer_load_dwordx4 v[120:123], v1, s[8:11], s16 offen offset:1024 sc1
e2_y:
    s_barrier
    s_cmp_ge_u32 s12, 8
    s_cbranch_scc1 x1_hi
    s_mul_i32 s22, s48, 6144
    s_add_u32 s22, s22, s98
    s_mul_i32 s24, s48, 24576
    s_add_u32 s24, s24, s99
    s_add_u32 s22, s22, s87
    s_add_u32 s22, s22, 18063360
    s_mul_i32 s4, s21, 1024
    s_add_u32 s22, s22, s4
    s_lshl_b32 s4, s21, 10
    s_add_u32 s24, s24, s4
    s_add_u32 m0, s24, 0
    s_add_u32 s23, s22, 0
    buffer_load_dwordx4 v1, s[8:11], s23 offen sc1 lds
    s_add_u32 m0, s24, 8192
    s_add_u32 s23, s22, 2048
    buffer_load_dwordx4 v1, s[8:11], s23 offen sc1 lds
    s_add_u32 m0, s24, 16384
    s_add_u32 s23, s22, 4096
    buffer_load_dwordx4 v1, s[8:11], s23 offen sc1 lds
    s_branch x1_x
x1_hi:
    s_mul_i32 s22, s49, 6144
    s_add_u32 s22, s22, s98
    s_mul_i32 s24, s49, 24576
    s_add_u32 s24, s24, s99
    s_add_u32 s22, s22, s87
    s_add_u32 s22, s22, 18063360
    s_add_u32 m0, s24, 0
    s_add_u32 s23, s22, 0
    buffer_load_dwordx4 v1, s[8:11], s23 offen sc1 lds
    s_add_u32 m0, s24, 1024
    s_add_u32 s23, s22, 1024
    buffer_load_dwordx4 v1, s[8:11], s23 offen sc1 lds
    s_add_u32 m0, s24, 8192
    s_add_u32 s23, s22, 2048
    buffer_load_dwordx4 v1, s[8:11], s23 offen sc1 lds
    s_add_u32 m0, s24, 9216
    s_add_u32 s23, s22, 3072
    buffer_load_dwordx4 v1, s[8:11], s23 offen sc1 lds
    s_add_u32 m0, s24, 16384
    s_add_u32 s23, s22, 4096
    buffer_load_dwordx4 v1, s[8:11], s23 offen sc1 lds
    s_add_u32 m0, s24, 17408
    s_add_u32 s23, s22, 5120
    buffer_load_dwordx4 v1, s[8:11], s23 offen sc1 lds
    s_mul_i32 s22, s50, 6144
    s_add_u32 s22, s22, s98
    s_mul_i32 s24, s50, 24576
    s_add_u32 s24, s24, s99
    s_add_u32 s22, s22, s87
    s_add_u32 s22, s22, 18063360
    s_add_u32 m0, s24, 0
    s_add_u32 s23, s22, 0
    buffer_load_dwordx4 v1, s[8:11], s23 offen sc1 lds
    s_add_u32 m0, s24, 1024
    s_add_u32 s23, s22, 1024
    buffer_load_dwordx4 v1, s[8:11], s23 offen sc1 lds
    s_add_u32 m0, s24, 8192
    s_add_u32 s23, s22, 2048
    buffer_load_dwordx4 v1, s[8:11], s23 offen sc1 lds
    s_add_u32 m0, s24, 9216
    s_add_u32 s23, s22, 3072
    buffer_load_dwordx4 v1, s[8:11], s23 offen sc1 lds
    s_add_u32 m0, s24, 16384
    s_add_u32 s23, s22, 4096
    buffer_load_dwordx4 v1, s[8:11], s23 offen sc1 lds
    s_add_u32 m0, s24, 17408
    s_add_u32 s23, s22, 5120
    buffer_load_dwordx4 v1, s[8:11], s23 offen sc1 lds
x1_x:
    s_lshl_b32 s4, s20, 2
    v_mov_b32 v165, s4
    s_mul_i32 s16, s13, 12
    s_add_u32 s16, s16, s28
    s_mul_i32 s16, s16, 55296
    s_add_u32 s16, s16, 2727936
    s_mul_i32 s4, s48, 18432
    s_add_u32 s30, s4, s16
    s_mul_i32 s4, s48, 24576
    s_add_u32 s4, s4, 3072
    v_add_u32 v160, s4, v1
    s_mul_i32 s4, s49, 18432
    s_add_u32 s31, s4, s16
    s_mul_i32 s4, s49, 24576
    s_add_u32 s4, s4, 3072
    v_add_u32 v161, s4, v1
    s_mul_i32 s4, s50, 18432
    s_add_u32 s32, s4, s16
    s_mul_i32 s4, s50, 24576
    s_add_u32 s4, s4, 3072
    v_add_u32 v162, s4, v1
    s_lshl_b32 s4, s21, 3
    s_lshl_b32 s27, 1, s4
    s_mov_b32 s18, s21
    v_mov_b32 v166, 524
    s_cmp_ge_u32 s12, 8
    s_cbranch_scc1 s3_hi
    s_waitcnt vmcnt(0)
    s_barrier
    s_cmp_lt_u32 s12, 7
    s_cbranch_scc1 s3_filled
    s_branch s3_fill
s3_hi:
    s_barrier
    v_mov_b32 v5, 0x100
    s_waitcnt vmcnt(6)
    s_mov_b64 exec, 1
    ds_add_u32 v167, v5 offset:524
    s_mov_b64 exec, -1
    v_mov_b32 v5, 0x10000
    s_waitcnt vmcnt(0)
    s_mov_b64 exec, 1
    ds_add_u32 v167, v5 offset:524
    s_mov_b64 exec, -1
    s_setprio 3
    s_lshl_b32 s4, s20, 11
    s_add_u32 s4, s4, 3072
    v_add_u32 v164, s4, v1
    v_add_u32 v163, 40960, v164
    v_mov_b32 v124, 0x3f803f80
    v_mov_b32 v125, 0x3f803f80
    v_mov_b32 v126, 0x3f803f80
    v_mov_b32 v127, 0x3f803f80
    ds_read_b128 v[52:55], v164 offset:0
    ds_read_b128 v[56:59], v164 offset:1024
    ds_read_b128 v[60:63], v164 offset:8192
    ds_read_b128 v[64:67], v164 offset:9216
    ds_read_b128 v[68:71], v164 offset:16384
    ds_read_b128 v[72:75], v164 offset:17408
    ds_read_b128 v[76:79], v164 offset:24576
    ds_read_b128 v[80:83], v164 offset:25600
    ds_read_b128 v[84:87], v164 offset:32768
    ds_read_b128 v[88:91], v164 offset:33792
    ds_read_b128 v[92:95], v163 offset:0
    ds_read_b128 v[96:99], v163 offset:1024
    s_waitcnt lgkmcnt(11)
    v_mfma_f32_16x16x32_bf16 v[4:7], v[124:127], v[52:55], 0
    v_mfma_f32_16x16x32_bf16 v[8:11], v[52:55], v[52:55], 0
    ds_read_b128 v[100:103], v163 offset:8192
    s_waitcnt lgkmcnt(11)
    v_mfma_f32_16x16x32_bf16 v[4:7], v[124:127], v[56:59], v[4:7]
    v_mfma_f32_16x16x32_bf16 v[8:11], v[56:59], v[56:59], v[8:11]
    ds_read_b128 v[104:107], v163 offset:9216
    s_waitcnt lgkmcnt(11)
    v_mfma_f32_16x16x32_bf16 v[4:7], v[124:127], v[60:63], v[4:7]
    v_mfma_f32_16x16x32_bf16 v[8:11], v[60:63], v[60:63], v[8:11]
    ds_read_b128 v[108:111], v163 offset:16384
    s_waitcnt lgkmcnt(11)
    v_mfma_f32_16x16x32_bf16 v[4:7], v[124:127], v[64:67], v[4:7]
    v_mfma_f32_16x16x32_bf16 v[8:11], v[64:67], v[64:67], v[8:11]
    ds_read_b128 v[112:115], v163 offset:17408
    s_waitcnt lgkmcnt(11)
    v_mfma_f32_16x16x32_bf16 v[4:7], v[124:127], v[68:71], v[4:7]
    v_mfma_f32_16x16x32_bf16 v[8:11], v[68:71], v[68:71], v[8:11]
    ds_read_b128 v[116:119], v163 offset:24576
    s_waitcnt lgkmcnt(11)
    v_mfma_f32_16x16x32_bf16 v[4:7], v[124:127], v[72:75], v[4:7]
    v_mfma_f32_16x16x32_bf16 v[8:11], v[72:75], v[72:75], v[8:11]
    ds_read_b128 v[120:123], v163 offset:25600
    s_waitcnt lgkmcnt(11)
    v_mfma_f32_16x16x32_bf16 v[4:7], v[124:127], v[76:79], v[4:7]
    v_mfma_f32_16x16x32_bf16 v[8:11], v[76:79], v[76:79], v[8:11]
    s_waitcnt lgkmcnt(10)
    v_mfma_f32_16x16x32_bf16 v[4:7], v[124:127], v[80:83], v[4:7]
    v_mfma_f32_16x16x32_bf16 v[8:11], v[80:83], v[80:83], v[8:11]
    s_waitcnt lgkmcnt(9)
    v_mfma_f32_16x16x32_bf16 v[4:7], v[124:127], v[84:87], v[4:7]
    v_mfma_f32_16x16x32_bf16 v[8:11], v[84:87], v[84:87], v[8:11]
    s_waitcnt lgkmcnt(8)
    v_mfma_f32_16x16x32_bf16 v[4:7], v[124:127], v[88:91], v[4:7]
    v_mfma_f32_16x16x32_bf16 v[8:11], v[88:91], v[88:91], v[8:11]
    s_waitcnt lgkmcnt(7)
    v_mfma_f32_16x16x32_bf16 v[4:7], v[124:127], v[92:95], v[4:7]
    v_mfma_f32_16x16x32_bf16 v[8:11], v[92:95], v[92:95], v[8:11]
    s_waitcnt lgkmcnt(6)
    v_mfma_f32_16x16x32_bf16 v[4:7], v[124:127], v[96:99], v[4:7]
    v_mfma_f32_16x16x32_bf16 v[8:11], v[96:99], v[96:99], v[8:11]
    s_waitcnt lgkmcnt(5)
    v_mfma_f32_16x16x32_bf16 v[4:7], v[124:127], v[100:103], v[4:7]
    v_mfma_f32_16x16x32_bf16 v[8:11], v[100:103], v[100:103], v[8:11]
    s_waitcnt lgkmcnt(4)
    v_mfma_f32_16x16x32_bf16 v[4:7], v[124:127], v[104:107], v[4:7]
    v_mfma_f32_16x16x32_bf16 v[8:11], v[104:107], v[104:107], v[8:11]
    s_waitcnt lgkmcnt(3)
    v_mfma_f32_16x16x32_bf16 v[4:7], v[124:127], v[108:111], v[4:7]
    v_mfma_f32_16x16x32_bf16 v[8:11], v[108:111], v[108:111], v[8:11]
    s_waitcnt lgkmcnt(2)
    v_mfma_f32_16x16x32_bf16 v[4:7], v[124:127], v[112:115], v[4:7]
    v_mfma_f32_16x16x32_bf16 v[8:11], v[112:115], v[112:115], v[8:11]
    s_waitcnt lgkmcnt(1)
    v_mfma_f32_16x16x32_bf16 v[4:7], v[124:127], v[116:119], v[4:7]
    v_mfma_f32_16x16x32_bf16 v[8:11], v[116:119], v[116:119], v[8:11]
    s_waitcnt lgkmcnt(0)
    v_mfma_f32_16x16x32_bf16 v[4:7], v[124:127], v[120:123], v[4:7]
    v_mfma_f32_16x16x32_bf16 v[8:11], v[120:123], v[120:123], v[8:11]
    s_mov_b32 s40, 0x22222222
    s_mov_b32 s41, 0x22222222
    s_mov_b32 s42, 0x44444444
    s_mov_b32 s43, 0x44444444
    s_mov_b32 s44, 0x88888888
    s_mov_b32 s45, 0x88888888
    s_nop 1
    v_cndmask_b32 v5, v8, v9, s[40:41]
    v_cndmask_b32 v5, v5, v10, s[42:43]
    v_cndmask_b32 v5, v5, v11, s[44:45]
    v_mul_f32 v4, 0x3ae38e39, v4
    v_mul_f32 v5, 0x3ae38e39, v5
    v_fma_f32 v5, -v4, v4, v5
    v_max_f32 v5, 0, v5
    v_add_f32 v5, 0x3727c5ac, v5
    v_rsq_f32 v6, v5
    s_lshl_b32 s4, s20, 6
    v_lshl_add_u32 v163, v2, 2, s4
    s_cmp_eq_u32 s12, 11
    s_cbranch_scc0 w2_n5
    s_add_u32 s6, s90, 1024
    s_mov_b32 s7, 81
    s_mov_b32 s5, 0
w2_w:
    s_mov_b32 s4, 0
    s_atomic_add s4, s[8:9], s6 glc
    s_waitcnt lgkmcnt(0)
    s_cmp_ge_u32 s4, s7
    s_cbranch_scc1 w2_w_ok
    s_add_u32 s5, s5, 1
    s_cmp_lt_u32 s5, 0x40000
    s_cbranch_scc1 w2_w
    s_endpgm
w2_w_ok:
w2_n5:
    v_mov_b32 v164, 0x1000000
    s_mov_b32 exec_lo, 0x00f0000f
    s_mov_b32 exec_hi, 0xf0000f00
    ds_write_b32 v163, v6
    s_mov_b64 exec, 1
    ds_add_u32 v167, v164 offset:516
    s_mov_b64 exec, -1
s3_tok:
    s_lshl_b32 s4, s18, 2
    s_lshr_b32 s33, 0x432100, s4
    s_and_b32 s33, s33, 15
    s_mov_b32 s5, 0
s3_tk:
    ds_read_b32 v163, v165 offset:528
    s_waitcnt lgkmcnt(0)
    v_readfirstlane_b32 s4, v163
    s_nop 0
    s_cmp_ge_u32 s4, s33
    s_cbranch_scc1 s3_tk_ok
    s_sleep 1
    s_add_u32 s5, s5, 1
    s_cmp_lt_u32 s5, 0x40000
    s_cbranch_scc1 s3_tk
    s_endpgm
s3_tk_ok:
s3_fill:
    s_mov_b32 s15, s30
    buffer_load_dwordx4 v[52:55], v1, s[8:11], s15 offen offset:0 sc1
    buffer_load_dwordx4 v[56:59], v1, s[8:11], s15 offen offset:1024 sc1
    buffer_load_dwordx4 v[60:63], v1, s[8:11], s15 offen offset:2048 sc1
    s_add_u32 s15, s15, 3072
    buffer_load_dwordx4 v[64:67], v1, s[8:11], s15 offen offset:0 sc1
    buffer_load_dwordx4 v[68:71], v1, s[8:11], s15 offen offset:1024 sc1
    buffer_load_dwordx4 v[72:75], v1, s[8:11], s15 offen offset:2048 sc1
    s_add_u32 s15, s15, 3072
    buffer_load_dwordx4 v[76:79], v1, s[8:11], s15 offen offset:0 sc1
    buffer_load_dwordx4 v[80:83], v1, s[8:11], s15 offen offset:1024 sc1
    buffer_load_dwordx4 v[84:87], v1, s[8:11], s15 offen offset:2048 sc1
    s_add_u32 s15, s15, 3072
    buffer_load_dwordx4 v[88:91], v1, s[8:11], s15 offen offset:0 sc1
    buffer_load_dwordx4 v[92:95], v1, s[8:11], s15 offen offset:1024 sc1
    buffer_load_dwordx4 v[96:99], v1, s[8:11], s15 offen offset:2048 sc1
    s_add_u32 s15, s15, 3072
    buffer_load_dwordx4 v[100:103], v1, s[8:11], s15 offen offset:0 sc1
    buffer_load_dwordx4 v[104:107], v1, s[8:11], s15 offen offset:1024 sc1
    buffer_load_dwordx4 v[108:111], v1, s[8:11], s15 offen offset:2048 sc1
    s_add_u32 s15, s15, 3072
    buffer_load_dwordx4 v[112:115], v1, s[8:11], s15 offen offset:0 sc1
    buffer_load_dwordx4 v[116:119], v1, s[8:11], s15 offen offset:1024 sc1
    buffer_load_dwordx4 v[120:123], v1, s[8:11], s15 offen offset:2048 sc1
s3_filled:
    v_mov_b32 v164, 1
    s_setprio 2
    s_cmp_lt_u32 s18, 3
    s_cbranch_scc1 s3_pass
    s_mov_b32 s5, 0
s3_w2:
    ds_read_b32 v163, v167 offset:516
    s_waitcnt lgkmcnt(0)
    v_readfirstlane_b32 s4, v163
    s_nop 0
    s_and_b32 s4, s4, 0xff
    s_cmp_eq_u32 s4, 0x4
    s_cbranch_scc1 s3_w2_ok
    s_sleep 1
    s_add_u32 s5, s5, 1
    s_cmp_lt_u32 s5, 0x40000
    s_cbranch_scc1 s3_w2
    s_endpgm
s3_w2_ok:
    s_setprio 1
s3_pass:
    ds_read_b128 v[124:127], v160 offset:0
    ds_read_b128 v[128:131], v160 offset:2048
    ds_read_b128 v[132:135], v160 offset:4096
    ds_read_b128 v[136:139], v160 offset:6144
    s_waitcnt vmcnt(17) lgkmcnt(0)
    v_mfma_f32_16x16x32_bf16 v[4:7], v[52:55], v[124:127], 0
    s_mov_b32 s15, s31
    ds_read_b128 v[140:143], v160 offset:1024
    v_mfma_f32_16x16x32_bf16 v[8:11], v[52:55], v[128:131], 0
    ds_read_b128 v[144:147], v160 offset:3072
    v_mfma_f32_16x16x32_bf16 v[12:15], v[52:55], v[132:135], 0
    s_waitcnt vmcnt(16)
    v_mfma_f32_16x16x32_bf16 v[16:19], v[52:55], v[136:139], 0
    buffer_load_dwordx4 v[52:55], v1, s[8:11], s15 offen offset:0 sc1
    v_mfma_f32_16x16x32_bf16 v[32:35], v[56:59], v[136:139], 0
    ds_read_b128 v[148:151], v160 offset:5120
    v_mfma_f32_16x16x32_bf16 v[28:31], v[56:59], v[132:135], 0
    ds_read_b128 v[152:155], v160 offset:7168
    v_mfma_f32_16x16x32_bf16 v[24:27], v[56:59], v[128:131], 0
    s_waitcnt vmcnt(16)
    v_mfma_f32_16x16x32_bf16 v[20:23], v[56:59], v[124:127], 0
    buffer_load_dwordx4 v[56:59], v1, s[8:11], s15 offen offset:1024 sc1
    v_mfma_f32_16x16x32_bf16 v[36:39], v[60:63], v[124:127], 0
    v_mfma_f32_16x16x32_bf16 v[40:43], v[60:63], v[128:131], 0
    v_mfma_f32_16x16x32_bf16 v[44:47], v[60:63], v[132:135], 0
    s_waitcnt vmcnt(16) lgkmcnt(0)
    v_mfma_f32_16x16x32_bf16 v[48:51], v[60:63], v[136:139], 0
    buffer_load_dwordx4 v[60:63], v1, s[8:11], s15 offen offset:2048 sc1
    v_mfma_f32_16x16x32_bf16 v[4:7], v[64:67], v[140:143], v[4:7]
    s_add_u32 s15, s15, 3072
    ds_read_b128 v[124:127], v160 offset:8192
    v_mfma_f32_16x16x32_bf16 v[8:11], v[64:67], v[144:147], v[8:11]
    ds_read_b128 v[128:131], v160 offset:10240
    v_mfma_f32_16x16x32_bf16 v[12:15], v[64:67], v[148:151], v[12:15]
    s_waitcnt vmcnt(16)
    v_mfma_f32_16x16x32_bf16 v[16:19], v[64:67], v[152:155], v[16:19]
    buffer_load_dwordx4 v[64:67], v1, s[8:11], s15 offen offset:0 sc1
    v_mfma_f32_16x16x32_bf16 v[32:35], v[68:71], v[152:155], v[32:35]
    ds_read_b128 v[132:135], v160 offset:12288
    v_mfma_f32_16x16x32_bf16 v[28:31], v[68:71], v[148:151], v[28:31]
    ds_read_b128 v[136:139], v160 offset:14336
    v_mfma_f32_16x16x32_bf16 v[24:27], v[68:71], v[144:147], v[24:27]
    s_waitcnt vmcnt(16)
    v_mfma_f32_16x16x32_bf16 v[20:23], v[68:71], v[140:143], v[20:23]
    buffer_load_dwordx4 v[68:71], v1, s[8:11], s15 offen offset:1024 sc1
    v_mfma_f32_16x16x32_bf16 v[36:39], v[72:75], v[140:143], v[36:39]
    v_mfma_f32_16x16x32_bf16 v[40:43], v[72:75], v[144:147], v[40:43]
    v_mfma_f32_16x16x32_bf16 v[44:47], v[72:75], v[148:151], v[44:47]
    s_waitcnt vmcnt(16) lgkmcnt(0)
    v_mfma_f32_16x16x32_bf16 v[48:51], v[72:75], v[152:155], v[48:51]
    buffer_load_dwordx4 v[72:75], v1, s[8:11], s15 offen offset:2048 sc1
    v_mfma_f32_16x16x32_bf16 v[4:7], v[76:79], v[124:127], v[4:7]
    s_add_u32 s15, s15, 3072
    ds_read_b128 v[140:143], v160 offset:9216
    v_mfma_f32_16x16x32_bf16 v[8:11], v[76:79], v[128:131], v[8:11]
    ds_read_b128 v[144:147], v160 offset:11264
    v_mfma_f32_16x16x32_bf16 v[12:15], v[76:79], v[132:135], v[12:15]
    s_waitcnt vmcnt(16)
    v_mfma_f32_16x16x32_bf16 v[16:19], v[76:79], v[136:139], v[16:19]
    buffer_load_dwordx4 v[76:79], v1, s[8:11], s15 offen offset:0 sc1
    v_mfma_f32_16x16x32_bf16 v[32:35], v[80:83], v[136:139], v[32:35]
    ds_read_b128 v[148:151], v160 offset:13312
    v_mfma_f32_16x16x32_bf16 v[28:31], v[80:83], v[132:135], v[28:31]
    ds_read_b128 v[152:155], v160 offset:15360
    v_mfma_f32_16x16x32_bf16 v[24:27], v[80:83], v[128:131], v[24:27]
    s_waitcnt vmcnt(16)
    v_mfma_f32_16x16x32_bf16 v[20:23], v[80:83], v[124:127], v[20:23]
    buffer_load_dwordx4 v[80:83], v1, s[8:11], s15 offen offset:1024 sc1
    v_mfma_f32_16x16x32_bf16 v[36:39], v[84:87], v[124:127], v[36:39]
    v_mfma_f32_16x16x32_bf16 v[40:43], v[84:87], v[128:131], v[40:43]
    v_mfma_f32_16x16x32_bf16 v[44:47], v[84:87], v[132:135], v[44:47]
    s_waitcnt vmcnt(16) lgkmcnt(0)
    v_mfma_f32_16x16x32_bf16 v[48:51], v[84:87], v[136:139], v[48:51]
    buffer_load_dwordx4 v[84:87], v1, s[8:11], s15 offen offset:2048 sc1
    v_mfma_f32_16x16x32_bf16 v[4:7], v[88:91], v[140:143], v[4:7]
    s_add_u32 s15, s15, 3072
    ds_read_b128 v[124:127], v160 offset:16384
    v_mfma_f32_16x16x32_bf16 v[8:11], v[88:91], v[144:147], v[8:11]
    ds_read_b128 v[128:131], v160 offset:18432
    v_mfma_f32_16x16x32_bf16 v[12:15], v[88:91], v[148:151], v[12:15]
    s_waitcnt vmcnt(16)
    v_mfma_f32_16x16x32_bf16 v[16:19], v[88:91], v[152:155], v[16:19]
    buffer_load_dwordx4 v[88:91], v1, s[8:11], s15 offen offset:0 sc1
    v_mfma_f32_16x16x32_bf16 v[32:35], v[92:95], v[152:155], v[32:35]
    ds_read_b128 v[132:135], v160 offset:20480
    v_mfma_f32_16x16x32_bf16 v[28:31], v[92:95], v[148:151], v[28:31]
    ds_read_b128 v[136:139], v160 offset:22528
    v_mfma_f32_16x16x32_bf16 v[24:27], v[92:95], v[144:147], v[24:27]
    s_waitcnt vmcnt(16)
    v_mfma_f32_16x16x32_bf16 v[20:23], v[92:95], v[140:143], v[20:23]
    buffer_load_dwordx4 v[92:95], v1, s[8:11], s15 offen offset:1024 sc1
    v_mfma_f32_16x16x32_bf16 v[36:39], v[96:99], v[140:143], v[36:39]
    v_mfma_f32_16x16x32_bf16 v[40:43], v[96:99], v[144:147], v[40:43]
    v_mfma_f32_16x16x32_bf16 v[44:47], v[96:99], v[148:151], v[44:47]
    s_waitcnt vmcnt(16) lgkmcnt(0)
    v_mfma_f32_16x16x32_bf16 v[48:51], v[96:99], v[152:155], v[48:51]
    buffer_load_dwordx4 v[96:99], v1, s[8:11], s15 offen offset:2048 sc1
    v_mfma_f32_16x16x32_bf16 v[4:7], v[100:103], v[124:127], v[4:7]
    s_add_u32 s15, s15, 3072
    ds_read_b128 v[140:143], v160 offset:17408
    v_mfma_f32_16x16x32_bf16 v[8:11], v[100:103], v[128:131], v[8:11]
    ds_read_b128 v[144:147], v160 offset:19456
    v_mfma_f32_16x16x32_bf16 v[12:15], v[100:103], v[132:135], v[12:15]
    s_waitcnt vmcnt(16)
    v_mfma_f32_16x16x32_bf16 v[16:19], v[100:103], v[136:139], v[16:19]
    buffer_load_dwordx4 v[100:103], v1, s[8:11], s15 offen offset:0 sc1
    v_mfma_f32_16x16x32_bf16 v[32:35], v[104:107], v[136:139], v[32:35]
    ds_read_b128 v[148:151], v160 offset:21504
    v_mfma_f32_16x16x32_bf16 v[28:31], v[104:107], v[132:135], v[28:31]
    ds_read_b128 v[152:155], v160 offset:23552
    v_mfma_f32_16x16x32_bf16 v[24:27], v[104:107], v[128:131], v[24:27]
    s_waitcnt vmcnt(16)
    ds_read_b32 v163, v166
    v_mfma_f32_16x16x32_bf16 v[20:23], v[104:107], v[124:127], v[20:23]
    buffer_load_dwordx4 v[104:107], v1, s[8:11], s15 offen offset:1024 sc1
    v_mfma_f32_16x16x32_bf16 v[36:39], v[108:111], v[124:127], v[36:39]
    v_mfma_f32_16x16x32_bf16 v[40:43], v[108:111], v[128:131], v[40:43]
    v_mfma_f32_16x16x32_bf16 v[44:47], v[108:111], v[132:135], v[44:47]
    s_waitcnt vmcnt(16) lgkmcnt(0)
    v_readfirstlane_b32 s4, v163
    v_mfma_f32_16x16x32_bf16 v[48:51], v[108:111], v[136:139], v[48:51]
    buffer_load_dwordx4 v[108:111], v1, s[8:11], s15 offen offset:2048 sc1
    s_andn2_b32 s4, 0x400, s4
    s_cbranch_scc1 s3_slow4
s3_back4:
    v_mfma_f32_16x16x32_bf16 v[4:7], v[112:115], v[140:143], v[4:7]
    s_add_u32 s15, s15, 3072
    ds_read_b128 v[124:127], v161 offset:0
    v_mfma_f32_16x16x32_bf16 v[8:11], v[112:115], v[144:147], v[8:11]
    ds_read_b128 v[128:131], v161 offset:2048
    v_mfma_f32_16x16x32_bf16 v[12:15], v[112:115], v[148:151], v[12:15]
    s_waitcnt vmcnt(16)
    v_mfma_f32_16x16x32_bf16 v[16:19], v[112:115], v[152:155], v[16:19]
    buffer_load_dwordx4 v[112:115], v1, s[8:11], s15 offen offset:0 sc1
    v_mfma_f32_16x16x32_bf16 v[32:35], v[116:119], v[152:155], v[32:35]
    ds_read_b128 v[132:135], v161 offset:4096
    v_mfma_f32_16x16x32_bf16 v[28:31], v[116:119], v[148:151], v[28:31]
    ds_read_b128 v[136:139], v161 offset:6144
    v_mfma_f32_16x16x32_bf16 v[24:27], v[116:119], v[144:147], v[24:27]
    s_waitcnt vmcnt(16)
    v_mfma_f32_16x16x32_bf16 v[20:23], v[116:119], v[140:143], v[20:23]
    buffer_load_dwordx4 v[116:119], v1, s[8:11], s15 offen offset:1024 sc1
    v_mfma_f32_16x16x32_bf16 v[36:39], v[120:123], v[140:143], v[36:39]
    v_mfma_f32_16x16x32_bf16 v[40:43], v[120:123], v[144:147], v[40:43]
    v_mfma_f32_16x16x32_bf16 v[44:47], v[120:123], v[148:151], v[44:47]
    s_waitcnt vmcnt(16) lgkmcnt(0)
    v_mfma_f32_16x16x32_bf16 v[48:51], v[120:123], v[152:155], v[48:51]
    buffer_load_dwordx4 v[120:123], v1, s[8:11], s15 offen offset:2048 sc1
    v_mfma_f32_16x16x32_bf16 v[4:7], v[52:55], v[124:127], v[4:7]
    s_mov_b32 s15, s32
    ds_read_b128 v[140:143], v161 offset:1024
    v_mfma_f32_16x16x32_bf16 v[8:11], v[52:55], v[128:131], v[8:11]
    ds_read_b128 v[144:147], v161 offset:3072
    v_mfma_f32_16x16x32_bf16 v[12:15], v[52:55], v[132:135], v[12:15]
    s_waitcnt vmcnt(16)
    v_mfma_f32_16x16x32_bf16 v[16:19], v[52:55], v[136:139], v[16:19]
    buffer_load_dwordx4 v[52:55], v1, s[8:11], s15 offen offset:0 sc1
    v_mfma_f32_16x16x32_bf16 v[32:35], v[56:59], v[136:139], v[32:35]
    ds_read_b128 v[148:151], v161 offset:5120
    v_mfma_f32_16x16x32_bf16 v[28:31], v[56:59], v[132:135], v[28:31]
    ds_read_b128 v[152:155], v161 offset:7168
    v_mfma_f32_16x16x32_bf16 v[24:27], v[56:59], v[128:131], v[24:27]
    s_waitcnt vmcnt(16)
    v_mfma_f32_16x16x32_bf16 v[20:23], v[56:59], v[124:127], v[20:23]
    buffer_load_dwordx4 v[56:59], v1, s[8:11], s15 offen offset:1024 sc1
    v_mfma_f32_16x16x32_bf16 v[36:39], v[60:63], v[124:127], v[36:39]
    v_mfma_f32_16x16x32_bf16 v[40:43], v[60:63], v[128:131], v[40:43]
    v_mfma_f32_16x16x32_bf16 v[44:47], v[60:63], v[132:135], v[44:47]
    s_waitcnt vmcnt(16) lgkmcnt(0)
    v_mfma_f32_16x16x32_bf16 v[48:51], v[60:63], v[136:139], v[48:51]
    buffer_load_dwordx4 v[60:63], v1, s[8:11], s15 offen offset:2048 sc1
    v_mfma_f32_16x16x32_bf16 v[4:7], v[64:67], v[140:143], v[4:7]
    s_add_u32 s15, s15, 3072
    ds_read_b128 v[124:127], v161 offset:8192
    v_mfma_f32_16x16x32_bf16 v[8:11], v[64:67], v[144:147], v[8:11]
    ds_read_b128 v[128:131], v161 offset:10240
    v_mfma_f32_16x16x32_bf16 v[12:15], v[64:67], v[148:151], v[12:15]
    s_waitcnt vmcnt(16)
    v_mfma_f32_16x16x32_bf16 v[16:19], v[64:67], v[152:155], v[16:19]
    buffer_load_dwordx4 v[64:67], v1, s[8:11], s15 offen offset:0 sc1
    v_mfma_f32_16x16x32_bf16 v[32:35], v[68:71], v[152:155], v[32:35]
    ds_read_b128 v[132:135], v161 offset:12288
    v_mfma_f32_16x16x32_bf16 v[28:31], v[68:71], v[148:151], v[28:31]
    ds_read_b128 v[136:139], v161 offset:14336
    v_mfma_f32_16x16x32_bf16 v[24:27], v[68:71], v[144:147], v[24:27]
    s_waitcnt vmcnt(16)
    v_mfma_f32_16x16x32_bf16 v[20:23], v[68:71], v[140:143], v[20:23]
    buffer_load_dwordx4 v[68:71], v1, s[8:11], s15 offen offset:1024 sc1
    v_mfma_f32_16x16x32_bf16 v[36:39], v[72:75], v[140:143], v[36:39]
    v_mfma_f32_16x16x32_bf16 v[40:43], v[72:75], v[144:147], v[40:43]
    v_mfma_f32_16x16x32_bf16 v[44:47], v[72:75], v[148:151], v[44:47]
    s_waitcnt vmcnt(16) lgkmcnt(0)
    v_mfma_f32_16x16x32_bf16 v[48:51], v[72:75], v[152:155], v[48:51]
    buffer_load_dwordx4 v[72:75], v1, s[8:11], s15 offen offset:2048 sc1
    v_mfma_f32_16x16x32_bf16 v[4:7], v[76:79], v[124:127], v[4:7]
    s_add_u32 s15, s15, 3072
    ds_read_b128 v[140:143], v161 offset:9216
    v_mfma_f32_16x16x32_bf16 v[8:11], v[76:79], v[128:131], v[8:11]
    ds_read_b128 v[144:147], v161 offset:11264
    v_mfma_f32_16x16x32_bf16 v[12:15], v[76:79], v[132:135], v[12:15]
    s_waitcnt vmcnt(16)
    v_mfma_f32_16x16x32_bf16 v[16:19], v[76:79], v[136:139], v[16:19]
    buffer_load_dwordx4 v[76:79], v1, s[8:11], s15 offen offset:0 sc1
    v_mfma_f32_16x16x32_bf16 v[32:35], v[80:83], v[136:139], v[32:35]
    ds_read_b128 v[148:151], v161 offset:13312
    v_mfma_f32_16x16x32_bf16 v[28:31], v[80:83], v[132:135], v[28:31]
    ds_read_b128 v[152:155], v161 offset:15360
    v_mfma_f32_16x16x32_bf16 v[24:27], v[80:83], v[128:131], v[24:27]
    s_waitcnt vmcnt(16)
    v_mfma_f32_16x16x32_bf16 v[20:23], v[80:83], v[124:127], v[20:23]
    buffer_load_dwordx4 v[80:83], v1, s[8:11], s15 offen offset:1024 sc1
    v_mfma_f32_16x16x32_bf16 v[36:39], v[84:87], v[124:127], v[36:39]
    v_mfma_f32_16x16x32_bf16 v[40:43], v[84:87], v[128:131], v[40:43]
    v_mfma_f32_16x16x32_bf16 v[44:47], v[84:87], v[132:135], v[44:47]
    s_waitcnt vmcnt(16) lgkmcnt(0)
    v_mfma_f32_16x16x32_bf16 v[48:51], v[84:87], v[136:139], v[48:51]
    buffer_load_dwordx4 v[84:87], v1, s[8:11], s15 offen offset:2048 sc1
    v_mfma_f32_16x16x32_bf16 v[4:7], v[88:91], v[140:143], v[4:7]
    s_add_u32 s15, s15, 3072
    ds_read_b128 v[124:127], v161 offset:16384
    v_mfma_f32_16x16x32_bf16 v[8:11], v[88:91], v[144:147], v[8:11]
    ds_read_b128 v[128:131], v161 offset:18432
    v_mfma_f32_16x16x32_bf16 v[12:15], v[88:91], v[148:151], v[12:15]
    s_waitcnt vmcnt(16)
    v_mfma_f32_16x16x32_bf16 v[16:19], v[88:91], v[152:155], v[16:19]
    buffer_load_dwordx4 v[88:91], v1, s[8:11], s15 offen offset:0 sc1
    v_mfma_f32_16x16x32_bf16 v[32:35], v[92:95], v[152:155], v[32:35]
    ds_read_b128 v[132:135], v161 offset:20480
    v_mfma_f32_16x16x32_bf16 v[28:31], v[92:95], v[148:151], v[28:31]
    ds_read_b128 v[136:139], v161 offset:22528
    v_mfma_f32_16x16x32_bf16 v[24:27], v[92:95], v[144:147], v[24:27]
    s_waitcnt vmcnt(16)
    v_mfma_f32_16x16x32_bf16 v[20:23], v[92:95], v[140:143], v[20:23]
    buffer_load_dwordx4 v[92:95], v1, s[8:11], s15 offen offset:1024 sc1
    v_mfma_f32_16x16x32_bf16 v[36:39], v[96:99], v[140:143], v[36:39]
    v_mfma_f32_16x16x32_bf16 v[40:43], v[96:99], v[144:147], v[40:43]
    v_mfma_f32_16x16x32_bf16 v[44:47], v[96:99], v[148:151], v[44:47]
    s_waitcnt vmcnt(16) lgkmcnt(0)
    v_mfma_f32_16x16x32_bf16 v[48:51], v[96:99], v[152:155], v[48:51]
    buffer_load_dwordx4 v[96:99], v1, s[8:11], s15 offen offset:2048 sc1
    v_mfma_f32_16x16x32_bf16 v[4:7], v[100:103], v[124:127], v[4:7]
    s_add_u32 s15, s15, 3072
    ds_read_b128 v[140:143], v161 offset:17408
    v_mfma_f32_16x16x32_bf16 v[8:11], v[100:103], v[128:131], v[8:11]
    ds_read_b128 v[144:147], v161 offset:19456
    v_mfma_f32_16x16x32_bf16 v[12:15], v[100:103], v[132:135], v[12:15]
    s_waitcnt vmcnt(16)
    v_mfma_f32_16x16x32_bf16 v[16:19], v[100:103], v[136:139], v[16:19]
    buffer_load_dwordx4 v[100:103], v1, s[8:11], s15 offen offset:0 sc1
    v_mfma_f32_16x16x32_bf16 v[32:35], v[104:107], v[136:139], v[32:35]
    ds_read_b128 v[148:151], v161 offset:21504
    v_mfma_f32_16x16x32_bf16 v[28:31], v[104:107], v[132:135], v[28:31]
    ds_read_b128 v[152:155], v161 offset:23552
    v_mfma_f32_16x16x32_bf16 v[24:27], v[104:107], v[128:131], v[24:27]
    s_waitcnt vmcnt(16)
    ds_read_b32 v163, v166
    v_mfma_f32_16x16x32_bf16 v[20:23], v[104:107], v[124:127], v[20:23]
    buffer_load_dwordx4 v[104:107], v1, s[8:11], s15 offen offset:1024 sc1
    v_mfma_f32_16x16x32_bf16 v[36:39], v[108:111], v[124:127], v[36:39]
    v_mfma_f32_16x16x32_bf16 v[40:43], v[108:111], v[128:131], v[40:43]
    v_mfma_f32_16x16x32_bf16 v[44:47], v[108:111], v[132:135], v[44:47]
    s_waitcnt vmcnt(16) lgkmcnt(0)
    v_readfirstlane_b32 s4, v163
    v_mfma_f32_16x16x32_bf16 v[48:51], v[108:111], v[136:139], v[48:51]
    buffer_load_dwordx4 v[108:111], v1, s[8:11], s15 offen offset:2048 sc1
    s_andn2_b32 s4, 0x40000, s4
    s_cbranch_scc1 s3_slow10
s3_back10:
    v_mfma_f32_16x16x32_bf16 v[4:7], v[112:115], v[140:143], v[4:7]
    s_add_u32 s15, s15, 3072
    ds_read_b128 v[124:127], v162 offset:0
    v_mfma_f32_16x16x32_bf16 v[8:11], v[112:115], v[144:147], v[8:11]
    ds_read_b128 v[128:131], v162 offset:2048
    v_mfma_f32_16x16x32_bf16 v[12:15], v[112:115], v[148:151], v[12:15]
    s_waitcnt vmcnt(16)
    v_mfma_f32_16x16x32_bf16 v[16:19], v[112:115], v[152:155], v[16:19]
    buffer_load_dwordx4 v[112:115], v1, s[8:11], s15 offen offset:0 sc1
    v_mfma_f32_16x16x32_bf16 v[32:35], v[116:119], v[152:155], v[32:35]
    ds_read_b128 v[132:135], v162 offset:4096
    v_mfma_f32_16x16x32_bf16 v[28:31], v[116:119], v[148:151], v[28:31]
    ds_read_b128 v[136:139], v162 offset:6144
    v_mfma_f32_16x16x32_bf16 v[24:27], v[116:119], v[144:147], v[24:27]
    s_waitcnt vmcnt(16)
    v_mfma_f32_16x16x32_bf16 v[20:23], v[116:119], v[140:143], v[20:23]
    buffer_load_dwordx4 v[116:119], v1, s[8:11], s15 offen offset:1024 sc1
    s_mov_b64 exec, 1
    ds_add_u32 v165, v164 offset:528
    s_mov_b64 exec, -1
    v_mfma_f32_16x16x32_bf16 v[36:39], v[120:123], v[140:143], v[36:39]
    v_mfma_f32_16x16x32_bf16 v[40:43], v[120:123], v[144:147], v[40:43]
    v_mfma_f32_16x16x32_bf16 v[44:47], v[120:123], v[148:151], v[44:47]
    s_waitcnt vmcnt(16) lgkmcnt(0)
    v_mfma_f32_16x16x32_bf16 v[48:51], v[120:123], v[152:155], v[48:51]
    buffer_load_dwordx4 v[120:123], v1, s[8:11], s15 offen offset:2048 sc1
    v_mfma_f32_16x16x32_bf16 v[4:7], v[52:55], v[124:127], v[4:7]
    ds_read_b128 v[140:143], v162 offset:1024
    v_mfma_f32_16x16x32_bf16 v[8:11], v[52:55], v[128:131], v[8:11]
    ds_read_b128 v[144:147], v162 offset:3072
    v_mfma_f32_16x16x32_bf16 v[12:15], v[52:55], v[132:135], v[12:15]
    s_waitcnt vmcnt(16)
    v_mfma_f32_16x16x32_bf16 v[16:19], v[52:55], v[136:139], v[16:19]
    v_mfma_f32_16x16x32_bf16 v[32:35], v[56:59], v[136:139], v[32:35]
    ds_read_b128 v[148:151], v162 offset:5120
    v_mfma_f32_16x16x32_bf16 v[28:31], v[56:59], v[132:135], v[28:31]
    ds_read_b128 v[152:155], v162 offset:7168
    v_mfma_f32_16x16x32_bf16 v[24:27], v[56:59], v[128:131], v[24:27]
    s_waitcnt vmcnt(15)
    v_mfma_f32_16x16x32_bf16 v[20:23], v[56:59], v[124:127], v[20:23]
    v_mfma_f32_16x16x32_bf16 v[36:39], v[60:63], v[124:127], v[36:39]
    v_mfma_f32_16x16x32_bf16 v[40:43], v[60:63], v[128:131], v[40:43]
    v_mfma_f32_16x16x32_bf16 v[44:47], v[60:63], v[132:135], v[44:47]
    s_waitcnt vmcnt(14) lgkmcnt(0)
    v_mfma_f32_16x16x32_bf16 v[48:51], v[60:63], v[136:139], v[48:51]
    v_mfma_f32_16x16x32_bf16 v[4:7], v[64:67], v[140:143], v[4:7]
    ds_read_b128 v[124:127], v162 offset:8192
    v_mfma_f32_16x16x32_bf16 v[8:11], v[64:67], v[144:147], v[8:11]
    ds_read_b128 v[128:131], v162 offset:10240
    v_mfma_f32_16x16x32_bf16 v[12:15], v[64:67], v[148:151], v[12:15]
    s_waitcnt vmcnt(13)
    v_mfma_f32_16x16x32_bf16 v[16:19], v[64:67], v[152:155], v[16:19]
    v_mfma_f32_16x16x32_bf16 v[32:35], v[68:71], v[152:155], v[32:35]
    ds_read_b128 v[132:135], v162 offset:12288
    v_mfma_f32_16x16x32_bf16 v[28:31], v[68:71], v[148:151], v[28:31]
    ds_read_b128 v[136:139], v162 offset:14336
    v_mfma_f32_16x16x32_bf16 v[24:27], v[68:71], v[144:147], v[24:27]
    s_waitcnt vmcnt(12)
    v_mfma_f32_16x16x32_bf16 v[20:23], v[68:71], v[140:143], v[20:23]
    v_mfma_f32_16x16x32_bf16 v[36:39], v[72:75], v[140:143], v[36:39]
    v_mfma_f32_16x16x32_bf16 v[40:43], v[72:75], v[144:147], v[40:43]
    v_mfma_f32_16x16x32_bf16 v[44:47], v[72:75], v[148:151], v[44:47]
    s_waitcnt vmcnt(11) lgkmcnt(0)
    v_mfma_f32_16x16x32_bf16 v[48:51], v[72:75], v[152:155], v[48:51]
    v_mfma_f32_16x16x32_bf16 v[4:7], v[76:79], v[124:127], v[4:7]
    ds_read_b128 v[140:143], v162 offset:9216
    v_mfma_f32_16x16x32_bf16 v[8:11], v[76:79], v[128:131], v[8:11]
    ds_read_b128 v[144:147], v162 offset:11264
    v_mfma_f32_16x16x32_bf16 v[12:15], v[76:79], v[132:135], v[12:15]
    s_waitcnt vmcnt(10)
    v_mfma_f32_16x16x32_bf16 v[16:19], v[76:79], v[136:139], v[16:19]
    v_mfma_f32_16x16x32_bf16 v[32:35], v[80:83], v[136:139], v[32:35]
    ds_read_b128 v[148:151], v162 offset:13312
    v_mfma_f32_16x16x32_bf16 v[28:31], v[80:83], v[132:135], v[28:31]
    ds_read_b128 v[152:155], v162 offset:15360
    v_mfma_f32_16x16x32_bf16 v[24:27], v[80:83], v[128:131], v[24:27]
    s_waitcnt vmcnt(9)
    v_mfma_f32_16x16x32_bf16 v[20:23], v[80:83], v[124:127], v[20:23]
    v_mfma_f32_16x16x32_bf16 v[36:39], v[84:87], v[124:127], v[36:39]
    v_mfma_f32_16x16x32_bf16 v[40:43], v[84:87], v[128:131], v[40:43]
    v_mfma_f32_16x16x32_bf16 v[44:47], v[84:87], v[132:135], v[44:47]
    s_waitcnt vmcnt(8) lgkmcnt(0)
    v_mfma_f32_16x16x32_bf16 v[48:51], v[84:87], v[136:139], v[48:51]
    v_mfma_f32_16x16x32_bf16 v[4:7], v[88:91], v[140:143], v[4:7]
    ds_read_b128 v[124:127], v162 offset:16384
    v_mfma_f32_16x16x32_bf16 v[8:11], v[88:91], v[144:147], v[8:11]
    ds_read_b128 v[128:131], v162 offset:18432
    v_mfma_f32_16x16x32_bf16 v[12:15], v[88:91], v[148:151], v[12:15]
    s_waitcnt vmcnt(7)
    v_mfma_f32_16x16x32_bf16 v[16:19], v[88:91], v[152:155], v[16:19]
    v_mfma_f32_16x16x32_bf16 v[32:35], v[92:95], v[152:155], v[32:35]
    ds_read_b128 v[132:135], v162 offset:20480
    v_mfma_f32_16x16x32_bf16 v[28:31], v[92:95], v[148:151], v[28:31]
    ds_read_b128 v[136:139], v162 offset:22528
    v_mfma_f32_16x16x32_bf16 v[24:27], v[92:95], v[144:147], v[24:27]
    s_waitcnt vmcnt(6)
    v_mfma_f32_16x16x32_bf16 v[20:23], v[92:95], v[140:143], v[20:23]
    v_mfma_f32_16x16x32_bf16 v[36:39], v[96:99], v[140:143], v[36:39]
    v_mfma_f32_16x16x32_bf16 v[40:43], v[96:99], v[144:147], v[40:43]
    v_mfma_f32_16x16x32_bf16 v[44:47], v[96:99], v[148:151], v[44:47]
    s_waitcnt vmcnt(5) lgkmcnt(0)
    v_mfma_f32_16x16x32_bf16 v[48:51], v[96:99], v[152:155], v[48:51]
    v_mfma_f32_16x16x32_bf16 v[4:7], v[100:103], v[124:127], v[4:7]
    ds_read_b128 v[140:143], v162 offset:17408
    v_mfma_f32_16x16x32_bf16 v[8:11], v[100:103], v[128:131], v[8:11]
    ds_read_b128 v[144:147], v162 offset:19456
    v_mfma_f32_16x16x32_bf16 v[12:15], v[100:103], v[132:135], v[12:15]
    s_waitcnt vmcnt(4)
    v_mfma_f32_16x16x32_bf16 v[16:19], v[100:103], v[136:139], v[16:19]
    v_mfma_f32_16x16x32_bf16 v[32:35], v[104:107], v[136:139], v[32:35]
    ds_read_b128 v[148:151], v162 offset:21504
    v_mfma_f32_16x16x32_bf16 v[28:31], v[104:107], v[132:135], v[28:31]
    ds_read_b128 v[152:155], v162 offset:23552
    v_mfma_f32_16x16x32_bf16 v[24:27], v[104:107], v[128:131], v[24:27]
    s_waitcnt vmcnt(3)
    v_mfma_f32_16x16x32_bf16 v[20:23], v[104:107], v[124:127], v[20:23]
    v_mfma_f32_16x16x32_bf16 v[36:39], v[108:111], v[124:127], v[36:39]
    v_mfma_f32_16x16x32_bf16 v[40:43], v[108:111], v[128:131], v[40:43]
    v_mfma_f32_16x16x32_bf16 v[44:47], v[108:111], v[132:135], v[44:47]
    s_waitcnt vmcnt(2) lgkmcnt(0)
    v_mfma_f32_16x16x32_bf16 v[48:51], v[108:111], v[136:139], v[48:51]
    v_mfma_f32_16x16x32_bf16 v[4:7], v[112:115], v[140:143], v[4:7]
    v_mfma_f32_16x16x32_bf16 v[8:11], v[112:115], v[144:147], v[8:11]
    v_mfma_f32_16x16x32_bf16 v[12:15], v[112:115], v[148:151], v[12:15]
    s_waitcnt vmcnt(1)
    v_mfma_f32_16x16x32_bf16 v[16:19], v[112:115], v[152:155], v[16:19]
    v_mfma_f32_16x16x32_bf16 v[32:35], v[116:119], v[152:155], v[32:35]
    v_mfma_f32_16x16x32_bf16 v[28:31], v[116:119], v[148:151], v[28:31]
    v_mfma_f32_16x16x32_bf16 v[24:27], v[116:119], v[144:147], v[24:27]
    s_waitcnt vmcnt(0)
    v_mfma_f32_16x16x32_bf16 v[20:23], v[116:119], v[140:143], v[20:23]
    v_mfma_f32_16x16x32_bf16 v[36:39], v[120:123], v[140:143], v[36:39]
    v_mfma_f32_16x16x32_bf16 v[40:43], v[120:123], v[144:147], v[40:43]
    v_mfma_f32_16x16x32_bf16 v[44:47], v[120:123], v[148:151], v[44:47]
    v_mfma_f32_16x16x32_bf16 v[48:51], v[120:123], v[152:155], v[48:51]
    s_setprio 0
    s_lshr_b32 s24, s28, 1
    s_mul_i32 s24, s24, 3
    s_and_b32 s25, s28, 1
    s_cmp_ge_u32 s18, 3
    s_cbranch_scc1 s3_epib
    s_mov_b32 s5, 0
s3_w1:
    ds_read_b32 v163, v167 offset:516
    s_waitcnt lgkmcnt(0)
    v_readfirstlane_b32 s4, v163
    s_nop 0
    s_and_b32 s4, s4, 0xff000000
    s_cmp_eq_u32 s4, 0x4000000
    s_cbranch_scc1 s3_w1_ok
    s_sleep 1
    s_add_u32 s5, s5, 1
    s_cmp_lt_u32 s5, 0x40000
    s_cbranch_scc1 s3_w1
    s_endpgm
s3_w1_ok:
    v_lshlrev_b32 v163, 2, v2
    ds_read_b32 v156, v163 offset:0
    ds_read_b32 v157, v163 offset:64
    ds_read_b32 v158, v163 offset:128
    ds_read_b32 v159, v163 offset:192
    s_lshl_b32 s4, s25, 1
    s_add_u32 s4, s4, s24
    s_lshr_b32 s6, s4, 1
    s_lshl_b32 s6, s6, 13
    s_and_b32 s4, s4, 1
    s_lshl_b32 s4, s4, 10
    s_add_u32 s4, s4, s6
    s_add_u32 s4, s4, 76800
    s_add_u32 s5, s24, 1
    s_lshr_b32 s6, s5, 1
    s_lshl_b32 s6, s6, 13
    s_and_b32 s5, s5, 1
    s_lshl_b32 s5, s5, 10
    s_add_u32 s5, s5, s6
    s_lshl_b32 s6, s25, 3
    s_add_u32 s5, s5, s6
    s_add_u32 s5, s5, 76800
    s_waitcnt lgkmcnt(0)
    v_add_u32 v163, s4, v1
    v_add_u32 v164, s5, v1
    v_mul_f32 v152, 0xbfb8aa3b, v156
    v_mul_f32 v153, 0xbfb8aa3b, v157
    v_mul_f32 v154, 0xbfb8aa3b, v158
    v_mul_f32 v155, 0xbfb8aa3b, v159
    v_mul_f32 v124, v4, v152
    v_mul_f32 v125, v5, v152
    v_mul_f32 v126, v6, v152
    v_mul_f32 v127, v7, v152
    v_mul_f32 v128, v20, v152
    v_mul_f32 v129, v21, v152
    v_mul_f32 v130, v22, v152
    v_mul_f32 v131, v23, v152
    v_exp_f32 v124, v124
    v_exp_f32 v125, v125
    v_exp_f32 v126, v126
    v_exp_f32 v127, v127
    v_exp_f32 v128, v128
    v_exp_f32 v129, v129
    v_exp_f32 v130, v130
    v_exp_f32 v131, v131
    v_add_f32 v124, 1.0, v124
    v_add_f32 v125, 1.0, v125
    v_add_f32 v126, 1.0, v126
    v_add_f32 v127, 1.0, v127
    v_add_f32 v128, 1.0, v128
    v_add_f32 v129, 1.0, v129
    v_add_f32 v130, 1.0, v130
    v_add_f32 v131, 1.0, v131
    v_rcp_f32 v124, v124
    v_rcp_f32 v125, v125
    v_rcp_f32 v126, v126
    v_rcp_f32 v127, v127
    v_rcp_f32 v128, v128
    v_rcp_f32 v129, v129
    v_rcp_f32 v130, v130
    v_rcp_f32 v131, v131
    v_mul_f32 v124, v4, v124
    v_mul_f32 v125, v5, v125
    v_mul_f32 v126, v6, v126
    v_mul_f32 v127, v7, v127
    v_mul_f32 v128, v20, v128
    v_mul_f32 v129, v21, v129
    v_mul_f32 v130, v22, v130
    v_mul_f32 v131, v23, v131
    v_cvt_pk_bf16_f32 v132, v124, v125
    v_cvt_pk_bf16_f32 v133, v126, v127
    v_cvt_pk_bf16_f32 v134, v128, v129
    v_cvt_pk_bf16_f32 v135, v130, v131
    ds_write_b128 v163, v[132:135] offset:0
    v_mul_f32 v124, v8, v153
    v_mul_f32 v125, v9, v153
    v_mul_f32 v126, v10, v153
    v_mul_f32 v127, v11, v153
    v_mul_f32 v128, v24, v153
    v_mul_f32 v129, v25, v153
    v_mul_f32 v130, v26, v153
    v_mul_f32 v131, v27, v153
    v_exp_f32 v124, v124
    v_exp_f32 v125, v125
    v_exp_f32 v126, v126
    v_exp_f32 v127, v127
    v_exp_f32 v128, v128
    v_exp_f32 v129, v129
    v_exp_f32 v130, v130
    v_exp_f32 v131, v131
    v_add_f32 v124, 1.0, v124
    v_add_f32 v125, 1.0, v125
    v_add_f32 v126, 1.0, v126
    v_add_f32 v127, 1.0, v127
    v_add_f32 v128, 1.0, v128
    v_add_f32 v129, 1.0, v129
    v_add_f32 v130, 1.0, v130
    v_add_f32 v131, 1.0, v131
    v_rcp_f32 v124, v124
    v_rcp_f32 v125, v125
    v_rcp_f32 v126, v126
    v_rcp_f32 v127, v127
    v_rcp_f32 v128, v128
    v_rcp_f32 v129, v129
    v_rcp_f32 v130, v130
    v_rcp_f32 v131, v131
    v_mul_f32 v124, v8, v124
    v_mul_f32 v125, v9, v125
    v_mul_f32 v126, v10, v126
    v_mul_f32 v127, v11, v127
    v_mul_f32 v128, v24, v128
    v_mul_f32 v129, v25, v129
    v_mul_f32 v130, v26, v130
    v_mul_f32 v131, v27, v131
    v_cvt_pk_bf16_f32 v136, v124, v125
    v_cvt_pk_bf16_f32 v137, v126, v127
    v_cvt_pk_bf16_f32 v138, v128, v129
    v_cvt_pk_bf16_f32 v139, v130, v131
    ds_write_b128 v163, v[136:139] offset:2048
    v_mul_f32 v124, v12, v154
    v_mul_f32 v125, v13, v154
    v_mul_f32 v126, v14, v154
    v_mul_f32 v127, v15, v154
    v_mul_f32 v128, v28, v154
    v_mul_f32 v129, v29, v154
    v_mul_f32 v130, v30, v154
    v_mul_f32 v131, v31, v154
    v_exp_f32 v124, v124
    v_exp_f32 v125, v125
    v_exp_f32 v126, v126
    v_exp_f32 v127, v127
    v_exp_f32 v128, v128
    v_exp_f32 v129, v129
    v_exp_f32 v130, v130
    v_exp_f32 v131, v131
    v_add_f32 v124, 1.0, v124
    v_add_f32 v125, 1.0, v125
    v_add_f32 v126, 1.0, v126
    v_add_f32 v127, 1.0, v127
    v_add_f32 v128, 1.0, v128
    v_add_f32 v129, 1.0, v129
    v_add_f32 v130, 1.0, v130
    v_add_f32 v131, 1.0, v131
    v_rcp_f32 v124, v124
    v_rcp_f32 v125, v125
    v_rcp_f32 v126, v126
    v_rcp_f32 v127, v127
    v_rcp_f32 v128, v128
    v_rcp_f32 v129, v129
    v_rcp_f32 v130, v130
    v_rcp_f32 v131, v131
    v_mul_f32 v124, v12, v124
    v_mul_f32 v125, v13, v125
    v_mul_f32 v126, v14, v126
    v_mul_f32 v127, v15, v127
    v_mul_f32 v128, v28, v128
    v_mul_f32 v129, v29, v129
    v_mul_f32 v130, v30, v130
    v_mul_f32 v131, v31, v131
    v_cvt_pk_bf16_f32 v140, v124, v125
    v_cvt_pk_bf16_f32 v141, v126, v127
    v_cvt_pk_bf16_f32 v142, v128, v129
    v_cvt_pk_bf16_f32 v143, v130, v131
    ds_write_b128 v163, v[140:143] offset:4096
    v_mul_f32 v124, v16, v155
    v_mul_f32 v125, v17, v155
    v_mul_f32 v126, v18, v155
    v_mul_f32 v127, v19, v155
    v_mul_f32 v128, v32, v155
    v_mul_f32 v129, v33, v155
    v_mul_f32 v130, v34, v155
    v_mul_f32 v131, v35, v155
    v_exp_f32 v124, v124
    v_exp_f32 v125, v125
    v_exp_f32 v126, v126
    v_exp_f32 v127, v127
    v_exp_f32 v128, v128
    v_exp_f32 v129, v129
    v_exp_f32 v130, v130
    v_exp_f32 v131, v131
    v_add_f32 v124, 1.0, v124
    v_add_f32 v125, 1.0, v125
    v_add_f32 v126, 1.0, v126
    v_add_f32 v127, 1.0, v127
    v_add_f32 v128, 1.0, v128
    v_add_f32 v129, 1.0, v129
    v_add_f32 v130, 1.0, v130
    v_add_f32 v131, 1.0, v131
    v_rcp_f32 v124, v124
    v_rcp_f32 v125, v125
    v_rcp_f32 v126, v126
    v_rcp_f32 v127, v127
    v_rcp_f32 v128, v128
    v_rcp_f32 v129, v129
    v_rcp_f32 v130, v130
    v_rcp_f32 v131, v131
    v_mul_f32 v124, v16, v124
    v_mul_f32 v125, v17, v125
    v_mul_f32 v126, v18, v126
    v_mul_f32 v127, v19, v127
    v_mul_f32 v128, v32, v128
    v_mul_f32 v129, v33, v129
    v_mul_f32 v130, v34, v130
    v_mul_f32 v131, v35, v131
    v_cvt_pk_bf16_f32 v144, v124, v125
    v_cvt_pk_bf16_f32 v145, v126, v127
    v_cvt_pk_bf16_f32 v146, v128, v129
    v_cvt_pk_bf16_f32 v147, v130, v131
    ds_write_b128 v163, v[144:147] offset:6144
    v_mul_f32 v124, v36, v152
    v_mul_f32 v125, v37, v152
    v_mul_f32 v126, v38, v152
    v_mul_f32 v127, v39, v152
    v_mul_f32 v128, v40, v153
    v_mul_f32 v129, v41, v153
    v_mul_f32 v130, v42, v153
    v_mul_f32 v131, v43, v153
    v_exp_f32 v124, v124
    v_exp_f32 v125, v125
    v_exp_f32 v126, v126
    v_exp_f32 v127, v127
    v_exp_f32 v128, v128
    v_exp_f32 v129, v129
    v_exp_f32 v130, v130
    v_exp_f32 v131, v131
    v_add_f32 v124, 1.0, v124
    v_add_f32 v125, 1.0, v125
    v_add_f32 v126, 1.0, v126
    v_add_f32 v127, 1.0, v127
    v_add_f32 v128, 1.0, v128
    v_add_f32 v129, 1.0, v129
    v_add_f32 v130, 1.0, v130
    v_add_f32 v131, 1.0, v131
    v_rcp_f32 v124, v124
    v_rcp_f32 v125, v125
    v_rcp_f32 v126, v126
    v_rcp_f32 v127, v127
    v_rcp_f32 v128, v128
    v_rcp_f32 v129, v129
    v_rcp_f32 v130, v130
    v_rcp_f32 v131, v131
    v_mul_f32 v124, v36, v124
    v_mul_f32 v125, v37, v125
    v_mul_f32 v126, v38, v126
    v_mul_f32 v127, v39, v127
    v_mul_f32 v128, v40, v128
    v_mul_f32 v129, v41, v129
    v_mul_f32 v130, v42, v130
    v_mul_f32 v131, v43, v131
    v_cvt_pk_bf16_f32 v132, v124, v125
    v_cvt_pk_bf16_f32 v133, v126, v127
    v_cvt_pk_bf16_f32 v134, v128, v129
    v_cvt_pk_bf16_f32 v135, v130, v131
    ds_write_b64 v164, v[132:133] offset:0
    ds_write_b64 v164, v[134:135] offset:2048
    v_mul_f32 v124, v44, v154
    v_mul_f32 v125, v45, v154
    v_mul_f32 v126, v46, v154
    v_mul_f32 v127, v47, v154
    v_mul_f32 v128, v48, v155
    v_mul_f32 v129, v49, v155
    v_mul_f32 v130, v50, v155
    v_mul_f32 v131, v51, v155
    v_exp_f32 v124, v124
    v_exp_f32 v125, v125
    v_exp_f32 v126, v126
    v_exp_f32 v127, v127
    v_exp_f32 v128, v128
    v_exp_f32 v129, v129
    v_exp_f32 v130, v130
    v_exp_f32 v131, v131
    v_add_f32 v124, 1.0, v124
    v_add_f32 v125, 1.0, v125
    v_add_f32 v126, 1.0, v126
    v_add_f32 v127, 1.0, v127
    v_add_f32 v128, 1.0, v128
    v_add_f32 v129, 1.0, v129
    v_add_f32 v130, 1.0, v130
    v_add_f32 v131, 1.0, v131
    v_rcp_f32 v124, v124
    v_rcp_f32 v125, v125
    v_rcp_f32 v126, v126
    v_rcp_f32 v127, v127
    v_rcp_f32 v128, v128
    v_rcp_f32 v129, v129
    v_rcp_f32 v130, v130
    v_rcp_f32 v131, v131
    v_mul_f32 v124, v44, v124
    v_mul_f32 v125, v45, v125
    v_mul_f32 v126, v46, v126
    v_mul_f32 v127, v47, v127
    v_mul_f32 v128, v48, v128
    v_mul_f32 v129, v49, v129
    v_mul_f32 v130, v50, v130
    v_mul_f32 v131, v51, v131
    v_cvt_pk_bf16_f32 v136, v124, v125
    v_cvt_pk_bf16_f32 v137, v126, v127
    v_cvt_pk_bf16_f32 v138, v128, v129
    v_cvt_pk_bf16_f32 v139, v130, v131
    ds_write_b64 v164, v[136:137] offset:4096
    ds_write_b64 v164, v[138:139] offset:6144
    v_mov_b32 v163, s27
    s_mov_b64 exec, 1
    ds_add_u32 v167, v163 offset:516
    s_mov_b64 exec, -1
    s_add_u32 s30, s30, 5308416
    v_add_u32 v160, 73728, v160
    s_add_u32 s31, s31, 5308416
    v_add_u32 v161, 73728, v161
    s_add_u32 s32, s32, 5308416
    v_add_u32 v162, 73728, v162
    s_add_u32 s18, s18, 3
    v_mov_b32 v166, 516
    s_branch s3_tok
s3_slow4:
    s_mov_b32 s5, 0
s3_sl4:
    ds_read_b32 v163, v166 offset:0
    s_waitcnt lgkmcnt(0)
    v_readfirstlane_b32 s4, v163
    s_nop 0
    s_and_b32 s4, s4, 0x400
    s_cmp_eq_u32 s4, 0x400
    s_cbranch_scc1 s3_sl4_ok
    s_sleep 1
    s_add_u32 s5, s5, 1
    s_cmp_lt_u32 s5, 0x40000
    s_cbranch_scc1 s3_sl4
    s_endpgm
s3_sl4_ok:
    s_branch s3_back4
s3_slow10:
    s_mov_b32 s5, 0
s3_sl10:
    ds_read_b32 v163, v166 offset:0
    s_waitcnt lgkmcnt(0)
    v_readfirstlane_b32 s4, v163
    s_nop 0
    s_and_b32 s4, s4, 0x40000
    s_cmp_eq_u32 s4, 0x40000
    s_cbranch_scc1 s3_sl10_ok
    s_sleep 1
    s_add_u32 s5, s5, 1
    s_cmp_lt_u32 s5, 0x40000
    s_cbranch_scc1 s3_sl10
    s_endpgm
s3_sl10_ok:
    s_branch s3_back10
s3_epib:
    s_setprio 3
    s_lshl_b32 s4, s13, 5
    s_add_u32 s4, s4, s14
    s_mul_i32 s4, s4, 12
    s_add_u32 s4, s4, s28
    s_mul_i32 s4, s4, 6144
    s_add_u32 s6, s4, s97
    s_add_u32 s7, s6, 4096
    v_mul_f32 v4, v4, v156
    v_mul_f32 v5, v5, v156
    v_mul_f32 v6, v6, v156
    v_mul_f32 v7, v7, v156
    v_cvt_pk_bf16_f32 v124, v4, v5
    v_cvt_pk_bf16_f32 v125, v6, v7
    v_mul_f32 v20, v20, v156
    v_mul_f32 v21, v21, v156
    v_mul_f32 v22, v22, v156
    v_mul_f32 v23, v23, v156
    v_cvt_pk_bf16_f32 v126, v20, v21
    v_cvt_pk_bf16_f32 v127, v22, v23
    buffer_store_dwordx4 v[124:127], v1, s[8:11], s6 offen offset:0 sc1
    v_mul_f32 v8, v8, v157
    v_mul_f32 v9, v9, v157
    v_mul_f32 v10, v10, v157
    v_mul_f32 v11, v11, v157
    v_cvt_pk_bf16_f32 v128, v8, v9
    v_cvt_pk_bf16_f32 v129, v10, v11
    v_mul_f32 v24, v24, v157
    v_mul_f32 v25, v25, v157
    v_mul_f32 v26, v26, v157
    v_mul_f32 v27, v27, v157
    v_cvt_pk_bf16_f32 v130, v24, v25
    v_cvt_pk_bf16_f32 v131, v26, v27
    buffer_store_dwordx4 v[128:131], v1, s[8:11], s6 offen offset:1024 sc1
    v_mul_f32 v12, v12, v158
    v_mul_f32 v13, v13, v158
    v_mul_f32 v14, v14, v158
    v_mul_f32 v15, v15, v158
    v_cvt_pk_bf16_f32 v132, v12, v13
    v_cvt_pk_bf16_f32 v133, v14, v15
    v_mul_f32 v28, v28, v158
    v_mul_f32 v29, v29, v158
    v_mul_f32 v30, v30, v158
    v_mul_f32 v31, v31, v158
    v_cvt_pk_bf16_f32 v134, v28, v29
    v_cvt_pk_bf16_f32 v135, v30, v31
    buffer_store_dwordx4 v[132:135], v1, s[8:11], s6 offen offset:2048 sc1
    v_mul_f32 v16, v16, v159
    v_mul_f32 v17, v17, v159
    v_mul_f32 v18, v18, v159
    v_mul_f32 v19, v19, v159
    v_cvt_pk_bf16_f32 v136, v16, v17
    v_cvt_pk_bf16_f32 v137, v18, v19
    v_mul_f32 v32, v32, v159
    v_mul_f32 v33, v33, v159
    v_mul_f32 v34, v34, v159
    v_mul_f32 v35, v35, v159
    v_cvt_pk_bf16_f32 v138, v32, v33
    v_cvt_pk_bf16_f32 v139, v34, v35
    buffer_store_dwordx4 v[136:139], v1, s[8:11], s6 offen offset:3072 sc1
    v_mul_f32 v36, v36, v156
    v_mul_f32 v37, v37, v156
    v_mul_f32 v38, v38, v156
    v_mul_f32 v39, v39, v156
    v_cvt_pk_bf16_f32 v140, v36, v37
    v_cvt_pk_bf16_f32 v141, v38, v39
    v_mul_f32 v40, v40, v157
    v_mul_f32 v41, v41, v157
    v_mul_f32 v42, v42, v157
    v_mul_f32 v43, v43, v157
    v_cvt_pk_bf16_f32 v142, v40, v41
    v_cvt_pk_bf16_f32 v143, v42, v43
    s_nop 0
    v_permlane16_swap_b32 v140, v142
    v_permlane16_swap_b32 v141, v143
    buffer_store_dwordx4 v[140:143], v1, s[8:11], s7 offen offset:0 sc1
    v_mul_f32 v44, v44, v158
    v_mul_f32 v45, v45, v158
    v_mul_f32 v46, v46, v158
    v_mul_f32 v47, v47, v158
    v_cvt_pk_bf16_f32 v144, v44, v45
    v_cvt_pk_bf16_f32 v145, v46, v47
    v_mul_f32 v48, v48, v159
    v_mul_f32 v49, v49, v159
    v_mul_f32 v50, v50, v159
    v_mul_f32 v51, v51, v159
    v_cvt_pk_bf16_f32 v146, v48, v49
    v_cvt_pk_bf16_f32 v147, v50, v51
    s_nop 0
    v_permlane16_swap_b32 v144, v146
    v_permlane16_swap_b32 v145, v147
    buffer_store_dwordx4 v[144:147], v1, s[8:11], s7 offen offset:1024 sc1
    s_mul_i32 s22, s14, 12
    s_add_u32 s4, s22, s28
    s_lshl_b32 s4, s4, 7
    s_add_u32 s6, s4, 27607040
    v_mov_b32 v4, 1
    s_and_b32 s23, s28, 12
    s_lshr_b32 s4, s13, 1
    s_add_u32 s23, s23, s4
    s_add_u32 s22, s22, s23
    s_lshl_b32 s7, s22, 7
    s_add_u32 s7, s7, 27607040
    s_and_b32 s29, s13, 1
    s_lshr_b32 s24, s23, 1
    s_mul_i32 s24, s24, 3
    s_and_b32 s25, s23, 1
    s_lshl_b32 s26, s29, 1
    v_mov_b32 v8, v3
    v_mov_b32 v9, 0
    s_cmp_eq_u32 s20, 2
    s_cbranch_scc1 s3_mix
    s_add_u32 s26, s26, s20
    s_mov_b32 s16, s26
    s_lshl_b32 s4, s25, 1
    s_add_u32 s24, s24, s4
    s_branch s3_adr
s3_mix:
    s_add_u32 s16, s29, 4
    s_add_u32 s24, s24, 1
    s_lshl_b32 s25, s25, 1
    v_lshrrev_b32 v8, 1, v3
    v_add_u32 v8, s25, v8
    v_and_b32 v9, 1, v3
s3_adr:
    s_mul_i32 s22, s22, 6
    s_add_u32 s16, s16, s22
    s_lshl_b32 s16, s16, 10
    s_add_u32 s16, s16, s97
    s_lshr_b32 s4, s24, 1
    s_lshl_b32 s4, s4, 2
    s_add_u32 s4, s4, s26
    s_lshl_b32 s4, s4, 1
    s_and_b32 s5, s24, 1
    s_add_u32 s4, s4, s5
    s_lshl_b32 s4, s4, 10
    s_add_u32 s4, s4, 3072
    v_lshlrev_b32 v7, 8, v8
    v_lshl_add_u32 v7, v2, 4, v7
    v_lshl_add_u32 v6, v9, 11, v7
    v_add_u32 v6, s4, v6
    v_mul_u32_u24 v9, 18432, v9
    s_lshl_b32 s4, s14, 2
    s_add_u32 s4, s4, s26
    s_mul_i32 s17, s4, 18432
    s_mov_b32 s39, 0x20000
    s_cmp_eq_u32 s86, 0
    s_cbranch_scc0 s3_fin
    s_mov_b32 s36, s8
    s_mov_b32 s37, s9
    s_mov_b32 s38, s10
    s_lshl_b32 s4, s24, 10
    s_add_u32 s17, s17, s4
    s_add_u32 s17, s17, 15704064
    s_branch s3_pu0
s3_fin:
    s_mov_b32 s36, s94
    s_mov_b32 s37, s95
    s_mov_b32 s38, 2359296
    s_lshl_b32 s4, s24, 6
    s_add_u32 s17, s17, s4
    v_mul_u32_u24 v7, 1152, v2
    v_lshl_add_u32 v7, v8, 4, v7
s3_pu0:
    v_add_u32 v7, v7, v9
s3_pub:
    s_cmp_eq_u32 s18, 5
    s_cbranch_scc0 s3_pu2
    s_mov_b64 exec, 1
    ds_add_u32 v165, v4 offset:528
    s_mov_b64 exec, -1
s3_pu2:
    s_waitcnt vmcnt(0)
    s_mov_b32 s3, 1
    s_atomic_add s3, s[8:9], s6
    s_cmp_eq_u32 s20, 3
    s_cbranch_scc1 s3_red_done
    ds_read_b128 v[8:11], v6
    s_mov_b32 s5, 0
s3_rw:
    s_mov_b32 s4, 0
    s_atomic_add s4, s[8:9], s7 glc
    s_waitcnt lgkmcnt(0)
    s_cmp_ge_u32 s4, s92
    s_cbranch_scc1 s3_rw_ok
    s_cmp_eq_u32 s18, 5
    s_cbranch_scc1 s3_rw_ns
    s_sleep 4
s3_rw_ns:
    s_add_u32 s5, s5, 1
    s_cmp_lt_u32 s5, 0x40000
    s_cbranch_scc1 s3_rw
    s_endpgm
s3_rw_ok:
    s_lshl_b32 s4, s86, 2
    s_add_u32 s4, s4, s21
    s_lshl_b32 s4, s4, 2
    s_lshr_b32 s33, 0x650065, s4
    s_and_b32 s33, s33, 15
    s_mov_b32 s5, 0
s3_t6r:
    ds_read_b32 v163, v165 offset:528
    s_waitcnt lgkmcnt(0)
    v_readfirstlane_b32 s4, v163
    s_nop 0
    s_cmp_ge_u32 s4, s33
    s_cbranch_scc1 s3_t6r_ok
    s_sleep 1
    s_add_u32 s5, s5, 1
    s_cmp_lt_u32 s5, 0x40000
    s_cbranch_scc1 s3_t6r
    s_endpgm
s3_t6r_ok:
    buffer_load_dwordx4 v[20:23], v1, s[8:11], s16 offen sc1
    s_add_u32 s16, s16, 2359296
    buffer_load_dwordx4 v[24:27], v1, s[8:11], s16 offen sc1
    s_add_u32 s16, s16, 2359296
    buffer_load_dwordx4 v[28:31], v1, s[8:11], s16 offen sc1
    s_add_u32 s16, s16, 2359296
    buffer_load_dwordx4 v[32:35], v1, s[8:11], s16 offen sc1
    s_add_u32 s16, s16, 2359296
    buffer_load_dwordx4 v[36:39], v1, s[8:11], s16 offen sc1
    s_add_u32 s16, s16, 2359296
    buffer_load_dwordx4 v[40:43], v1, s[8:11], s16 offen sc1
    s_add_u32 s16, s16, 2359296
    buffer_load_dwordx4 v[44:47], v1, s[8:11], s16 offen sc1
    s_add_u32 s16, s16, 2359296
    buffer_load_dwordx4 v[48:51], v1, s[8:11], s16 offen sc1
    s_waitcnt lgkmcnt(0)
    v_lshlrev_b32 v12, 16, v8
    v_and_b32 v13, 0xffff0000, v8
    v_lshlrev_b32 v14, 16, v9
    v_and_b32 v15, 0xffff0000, v9
    v_lshlrev_b32 v16, 16, v10
    v_and_b32 v17, 0xffff0000, v10
    v_lshlrev_b32 v18, 16, v11
    v_and_b32 v19, 0xffff0000, v11
    s_waitcnt vmcnt(7)
    v_lshlrev_b32 v8, 16, v20
    v_and_b32 v20, 0xffff0000, v20
    v_lshlrev_b32 v9, 16, v21
    v_and_b32 v21, 0xffff0000, v21
    v_lshlrev_b32 v10, 16, v22
    v_and_b32 v22, 0xffff0000, v22
    v_lshlrev_b32 v11, 16, v23
    v_and_b32 v23, 0xffff0000, v23
    v_add_f32 v12, v12, v8
    v_add_f32 v13, v13, v20
    v_add_f32 v14, v14, v9
    v_add_f32 v15, v15, v21
    v_add_f32 v16, v16, v10
    v_add_f32 v17, v17, v22
    v_add_f32 v18, v18, v11
    v_add_f32 v19, v19, v23
    s_waitcnt vmcnt(6)
    v_lshlrev_b32 v8, 16, v24
    v_and_b32 v24, 0xffff0000, v24
    v_lshlrev_b32 v9, 16, v25
    v_and_b32 v25, 0xffff0000, v25
    v_lshlrev_b32 v10, 16, v26
    v_and_b32 v26, 0xffff0000, v26
    v_lshlrev_b32 v11, 16, v27
    v_and_b32 v27, 0xffff0000, v27
    v_add_f32 v12, v12, v8
    v_add_f32 v13, v13, v24
    v_add_f32 v14, v14, v9
    v_add_f32 v15, v15, v25
    v_add_f32 v16, v16, v10
    v_add_f32 v17, v17, v26
    v_add_f32 v18, v18, v11
    v_add_f32 v19, v19, v27
    s_waitcnt vmcnt(5)
    v_lshlrev_b32 v8, 16, v28
    v_and_b32 v28, 0xffff0000, v28
    v_lshlrev_b32 v9, 16, v29
    v_and_b32 v29, 0xffff0000, v29
    v_lshlrev_b32 v10, 16, v30
    v_and_b32 v30, 0xffff0000, v30
    v_lshlrev_b32 v11, 16, v31
    v_and_b32 v31, 0xffff0000, v31
    v_add_f32 v12, v12, v8
    v_add_f32 v13, v13, v28
    v_add_f32 v14, v14, v9
    v_add_f32 v15, v15, v29
    v_add_f32 v16, v16, v10
    v_add_f32 v17, v17, v30
    v_add_f32 v18, v18, v11
    v_add_f32 v19, v19, v31
    s_waitcnt vmcnt(4)
    v_lshlrev_b32 v8, 16, v32
    v_and_b32 v32, 0xffff0000, v32
    v_lshlrev_b32 v9, 16, v33
    v_and_b32 v33, 0xffff0000, v33
    v_lshlrev_b32 v10, 16, v34
    v_and_b32 v34, 0xffff0000, v34
    v_lshlrev_b32 v11, 16, v35
    v_and_b32 v35, 0xffff0000, v35
    v_add_f32 v12, v12, v8
    v_add_f32 v13, v13, v32
    v_add_f32 v14, v14, v9
    v_add_f32 v15, v15, v33
    v_add_f32 v16, v16, v10
    v_add_f32 v17, v17, v34
    v_add_f32 v18, v18, v11
    v_add_f32 v19, v19, v35
    s_waitcnt vmcnt(3)
    v_lshlrev_b32 v8, 16, v36
    v_and_b32 v36, 0xffff0000, v36
    v_lshlrev_b32 v9, 16, v37
    v_and_b32 v37, 0xffff0000, v37
    v_lshlrev_b32 v10, 16, v38
    v_and_b32 v38, 0xffff0000, v38
    v_lshlrev_b32 v11, 16, v39
    v_and_b32 v39, 0xffff0000, v39
    v_add_f32 v12, v12, v8
    v_add_f32 v13, v13, v36
    v_add_f32 v14, v14, v9
    v_add_f32 v15, v15, v37
    v_add_f32 v16, v16, v10
    v_add_f32 v17, v17, v38
    v_add_f32 v18, v18, v11
    v_add_f32 v19, v19, v39
    s_waitcnt vmcnt(2)
    v_lshlrev_b32 v8, 16, v40
    v_and_b32 v40, 0xffff0000, v40
    v_lshlrev_b32 v9, 16, v41
    v_and_b32 v41, 0xffff0000, v41
    v_lshlrev_b32 v10, 16, v42
    v_and_b32 v42, 0xffff0000, v42
    v_lshlrev_b32 v11, 16, v43
    v_and_b32 v43, 0xffff0000, v43
    v_add_f32 v12, v12, v8
    v_add_f32 v13, v13, v40
    v_add_f32 v14, v14, v9
    v_add_f32 v15, v15, v41
    v_add_f32 v16, v16, v10
    v_add_f32 v17, v17, v42
    v_add_f32 v18, v18, v11
    v_add_f32 v19, v19, v43
    s_waitcnt vmcnt(1)
    v_lshlrev_b32 v8, 16, v44
    v_and_b32 v44, 0xffff0000, v44
    v_lshlrev_b32 v9, 16, v45
    v_and_b32 v45, 0xffff0000, v45
    v_lshlrev_b32 v10, 16, v46
    v_and_b32 v46, 0xffff0000, v46
    v_lshlrev_b32 v11, 16, v47
    v_and_b32 v47, 0xffff0000, v47
    v_add_f32 v12, v12, v8
    v_add_f32 v13, v13, v44
    v_add_f32 v14, v14, v9
    v_add_f32 v15, v15, v45
    v_add_f32 v16, v16, v10
    v_add_f32 v17, v17, v46
    v_add_f32 v18, v18, v11
    v_add_f32 v19, v19, v47
    s_waitcnt vmcnt(0)
    v_lshlrev_b32 v8, 16, v48
    v_and_b32 v48, 0xffff0000, v48
    v_lshlrev_b32 v9, 16, v49
    v_and_b32 v49, 0xffff0000, v49
    v_lshlrev_b32 v10, 16, v50
    v_and_b32 v50, 0xffff0000, v50
    v_lshlrev_b32 v11, 16, v51
    v_and_b32 v51, 0xffff0000, v51
    v_add_f32 v12, v12, v8
    v_add_f32 v13, v13, v48
    v_add_f32 v14, v14, v9
    v_add_f32 v15, v15, v49
    v_add_f32 v16, v16, v10
    v_add_f32 v17, v17, v50
    v_add_f32 v18, v18, v11
    v_add_f32 v19, v19, v51
    v_cvt_pk_bf16_f32 v8, v12, v13
    v_cvt_pk_bf16_f32 v9, v14, v15
    v_cvt_pk_bf16_f32 v10, v16, v17
    v_cvt_pk_bf16_f32 v11, v18, v19
    buffer_store_dwordx4 v[8:11], v7, s[36:39], s17 offen sc1
s3_red_done:
    s_setprio 0
    s_cmp_eq_u32 s86, 0
    s_cbranch_scc0 mega_fin
    s_waitcnt vmcnt(0)
    s_mov_b32 s86, 1
    s_mov_b32 s87, 2359296
    s_mov_b32 s91, 64
    s_mov_b32 s92, 16
    s_add_u32 s96, s96, 49152
    s_add_u32 s97, s97, 0
    s_lshl_b32 s6, s14, 2
    s_add_u32 s6, s6, s21
    s_lshl_b32 s6, s6, 7
    s_add_u32 s6, s6, 27656192
    s_mov_b32 s33, 6
    s_mov_b32 s35, 0
    s_cmp_eq_u32 s20, 3
    s_cbranch_scc1 nx_load
    s_mov_b32 s3, 1
    s_atomic_add s3, s[8:9], s6
    s_cmp_ge_u32 s12, 8
    s_cbranch_scc1 s1_wo
    s_mov_b32 s5, 0
nx_t1:
    ds_read_b32 v163, v165 offset:528
    s_waitcnt lgkmcnt(0)
    v_readfirstlane_b32 s4, v163
    s_nop 0
    s_cmp_ge_u32 s4, s33
    s_cbranch_scc1 nx_t1_ok
    s_sleep 1
    s_add_u32 s5, s5, 1
    s_cmp_lt_u32 s5, 0x40000
    s_cbranch_scc1 nx_t1
    s_endpgm
nx_t1_ok:
    s_branch nx_fill
nx_load:
    s_mov_b32 s5, 0
nx_t2:
    ds_read_b32 v163, v165 offset:528
    s_waitcnt lgkmcnt(0)
    v_readfirstlane_b32 s4, v163
    s_nop 0
    s_cmp_ge_u32 s4, s33
    s_cbranch_scc1 nx_t2_ok
    s_sleep 1
    s_add_u32 s5, s5, 1
    s_cmp_lt_u32 s5, 0x40000
    s_cbranch_scc1 nx_t2
    s_endpgm
nx_t2_ok:
    s_mov_b32 s7, 24
    s_setprio 3
    s_mov_b32 s5, 0
nx_w:
    s_mov_b32 s4, 0
    s_atomic_add s4, s[8:9], s6 glc
    s_waitcnt lgkmcnt(0)
    s_cmp_ge_u32 s4, s7
    s_cbranch_scc1 nx_w_ok
    s_cmp_eq_u32 s12, 11
    s_cbranch_scc1 nx_w_ns
    s_sleep 4
nx_w_ns:
    s_add_u32 s5, s5, 1
    s_cmp_lt_u32 s5, 0x40000
    s_cbranch_scc1 nx_w
    s_endpgm
nx_w_ok:
    s_lshr_b32 s4, s28, 2
    s_mul_i32 s22, s4, 6144
    s_mul_i32 s5, s14, 73728
    s_add_u32 s22, s22, s5
    s_add_u32 s22, s22, 15704064
    s_mul_i32 s24, s4, 24576
    s_add_u32 s24, s24, 3072
    s_add_u32 m0, s24, 0
    s_add_u32 s23, s22, 0
    buffer_load_dwordx4 v1, s[8:11], s23 offen offset:0 sc1 lds
    buffer_load_dwordx4 v1, s[8:11], s23 offen offset:1024 sc1 lds
    s_add_u32 m0, s24, 2048
    s_add_u32 s23, s22, 18432
    buffer_load_dwordx4 v1, s[8:11], s23 offen offset:0 sc1 lds
    buffer_load_dwordx4 v1, s[8:11], s23 offen offset:1024 sc1 lds
    s_add_u32 m0, s24, 4096
    s_add_u32 s23, s22, 36864
    buffer_load_dwordx4 v1, s[8:11], s23 offen offset:0 sc1 lds
    buffer_load_dwordx4 v1, s[8:11], s23 offen offset:1024 sc1 lds
    s_add_u32 m0, s24, 6144
    s_add_u32 s23, s22, 55296
    buffer_load_dwordx4 v1, s[8:11], s23 offen offset:0 sc1 lds
    buffer_load_dwordx4 v1, s[8:11], s23 offen offset:1024 sc1 lds
    s_add_u32 m0, s24, 8192
    s_add_u32 s23, s22, 2048
    buffer_load_dwordx4 v1, s[8:11], s23 offen offset:0 sc1 lds
    buffer_load_dwordx4 v1, s[8:11], s23 offen offset:1024 sc1 lds
    s_add_u32 m0, s24, 10240
    s_add_u32 s23, s22, 20480
    buffer_load_dwordx4 v1, s[8:11], s23 offen offset:0 sc1 lds
    buffer_load_dwordx4 v1, s[8:11], s23 offen offset:1024 sc1 lds
    s_add_u32 m0, s24, 12288
    s_add_u32 s23, s22, 38912
    buffer_load_dwordx4 v1, s[8:11], s23 offen offset:0 sc1 lds
    buffer_load_dwordx4 v1, s[8:11], s23 offen offset:1024 sc1 lds
    s_add_u32 m0, s24, 14336
    s_add_u32 s23, s22, 57344
    buffer_load_dwordx4 v1, s[8:11], s23 offen offset:0 sc1 lds
    buffer_load_dwordx4 v1, s[8:11], s23 offen offset:1024 sc1 lds
    s_add_u32 m0, s24, 16384
    s_add_u32 s23, s22, 4096
    buffer_load_dwordx4 v1, s[8:11], s23 offen offset:0 sc1 lds
    buffer_load_dwordx4 v1, s[8:11], s23 offen offset:1024 sc1 lds
    s_add_u32 m0, s24, 18432
    s_add_u32 s23, s22, 22528
    buffer_load_dwordx4 v1, s[8:11], s23 offen offset:0 sc1 lds
    buffer_load_dwordx4 v1, s[8:11], s23 offen offset:1024 sc1 lds
    s_add_u32 m0, s24, 20480
    s_add_u32 s23, s22, 40960
    buffer_load_dwordx4 v1, s[8:11], s23 offen offset:0 sc1 lds
    buffer_load_dwordx4 v1, s[8:11], s23 offen offset:1024 sc1 lds
    s_add_u32 m0, s24, 22528
    s_add_u32 s23, s22, 59392
    buffer_load_dwordx4 v1, s[8:11], s23 offen offset:0 sc1 lds
    buffer_load_dwordx4 v1, s[8:11], s23 offen offset:1024 sc1 lds
    s_lshl_b32 s4, s27, 2
    v_mov_b32 v5, s4
    s_waitcnt vmcnt(0)
    s_mov_b64 exec, 1
    ds_add_u32 v167, v5 offset:520
    s_mov_b64 exec, -1
    s_setprio 0
    s_cmp_eq_u32 s12, 11
    s_cbranch_scc1 s1_wo
    s_cmp_eq_u32 s12, 7
    s_cbranch_scc1 nx_go
nx_fill:
    s_mul_i32 s15, s13, 7
    s_add_u32 s15, s15, s12
    s_mul_i32 s15, s15, 36864
    s_add_u32 s15, s15, 0
    s_mul_i32 s4, s48, 12288
    s_add_u32 s30, s4, s15
    s_mul_i32 s4, s49, 12288
    s_add_u32 s31, s4, s15
    s_mul_i32 s4, s50, 12288
    s_add_u32 s32, s4, s15
    s_add_u32 s15, s30, 0
    buffer_load_dwordx4 v[40:43], v1, s[8:11], s15 offen offset:0 sc1
    buffer_load_dwordx4 v[44:47], v1, s[8:11], s15 offen offset:1024 sc1
    buffer_load_dwordx4 v[48:51], v1, s[8:11], s15 offen offset:2048 sc1
    buffer_load_dwordx4 v[52:55], v1, s[8:11], s15 offen offset:3072 sc1
    s_add_u32 s15, s30, 4096
    buffer_load_dwordx4 v[56:59], v1, s[8:11], s15 offen offset:0 sc1
    buffer_load_dwordx4 v[60:63], v1, s[8:11], s15 offen offset:1024 sc1
    buffer_load_dwordx4 v[64:67], v1, s[8:11], s15 offen offset:2048 sc1
    buffer_load_dwordx4 v[68:71], v1, s[8:11], s15 offen offset:3072 sc1
    s_add_u32 s15, s30, 8192
    buffer_load_dwordx4 v[72:75], v1, s[8:11], s15 offen offset:0 sc1
    buffer_load_dwordx4 v[76:79], v1, s[8:11], s15 offen offset:1024 sc1
    buffer_load_dwordx4 v[80:83], v1, s[8:11], s15 offen offset:2048 sc1
    buffer_load_dwordx4 v[84:87], v1, s[8:11], s15 offen offset:3072 sc1
    s_add_u32 s15, s31, 0
    buffer_load_dwordx4 v[88:91], v1, s[8:11], s15 offen offset:0 sc1
    buffer_load_dwordx4 v[92:95], v1, s[8:11], s15 offen offset:1024 sc1
    buffer_load_dwordx4 v[96:99], v1, s[8:11], s15 offen offset:2048 sc1
    buffer_load_dwordx4 v[100:103], v1, s[8:11], s15 offen offset:3072 sc1
    s_add_u32 s15, s31, 4096
    buffer_load_dwordx4 v[104:107], v1, s[8:11], s15 offen offset:0 sc1
    buffer_load_dwordx4 v[108:111], v1, s[8:11], s15 offen offset:1024 sc1
nx_go:
    s_mov_b32 s5, 0
nx_x0:
    ds_read_b32 v6, v167 offset:520
    s_waitcnt lgkmcnt(0)
    v_readfirstlane_b32 s4, v6
    s_nop 0
    s_and_b32 s4, s4, 0x4
    s_cmp_eq_u32 s4, 0x4
    s_cbranch_scc1 nx_x0_ok
    s_sleep 1
    s_add_u32 s5, s5, 1
    s_cmp_lt_u32 s5, 0x40000
    s_cbranch_scc1 nx_x0
    s_endpgm
nx_x0_ok:
    s_branch s1_go
mega_fin:
mega_end:
    s_endpgm
code_end:
.section .rodata,"a"
.p2align 6
.amdhsa_kernel interleave_layers__linear_attn_block__dense_activation_silu__prompt_kernel
  .amdhsa_next_free_vgpr 168
  .amdhsa_next_free_sgpr 102
  .amdhsa_accum_offset 168
  .amdhsa_group_segment_fixed_size 0
  .amdhsa_kernarg_size 72
  .amdhsa_user_sgpr_count 2
  .amdhsa_user_sgpr_kernarg_segment_ptr 1
  .amdhsa_system_sgpr_workgroup_id_x 1
  .amdhsa_float_denorm_mode_32 3
.end_amdhsa_kernel
```
